```python
import torch

def _softmax(x, axis=-1):
    return torch.softmax(x, dim=axis)
def _gelu(x):
    return torch.nn.functional.gelu(x, approximate="tanh")
def _silu(x):
    return torch.nn.functional.silu(x)
def _sigmoid(x):
    return torch.sigmoid(x)
def _layernorm(x, axis=-1, eps=1e-5):
    m = x.mean(dim=axis, keepdim=True)
    v = x.var(dim=axis, keepdim=True, unbiased=False)
    return (x - m) / torch.sqrt(v + eps)
def _scatter_add(tgt, idx, src, axis=0):
    return tgt.clone().index_add_(axis, idx, src)
def _segment_sum(src, seg, n):
    out = torch.zeros((n,) + src.shape[1:], dtype=src.dtype)
    return out.index_add_(0, seg, src)
def _pad(x, pw):
    flat = tuple(v for pair in reversed(pw) for v in pair)
    return torch.nn.functional.pad(x, flat)

kernel_name = 'standalone__deep_cross_fibinet__recsys'

def setup_inputs():

    _w = (lambda a: (lambda t: t.to(torch.bfloat16) if t.is_floating_point() else t)(torch.as_tensor(a)))
    B, F, D = 4096, 26, 64
    V = min(1000, 100000)
    Fr = max(F // 2, 1)
    H = min(F * D, 256)
    return {
        "idx": _w((lambda lo, hi, *s: torch.randint(lo, hi, s))(0, V, B, F).to(torch.int64)),
        "table": _w((lambda *s: torch.randn(*s, dtype=torch.bfloat16) * 1.6)(V, D)),
        "se_w1": _w((lambda *s: torch.randn(*s, dtype=torch.bfloat16) * 1.6)(F, Fr)),
        "se_w2": _w((lambda *s: torch.randn(*s, dtype=torch.bfloat16) * 1.6)(Fr, F)),
        "w_bi": _w((lambda *s: torch.randn(*s, dtype=torch.bfloat16) * 0.05)(D, D) * (D ** -0.5)),
        "w_cross": _w((lambda *s: torch.randn(*s, dtype=torch.bfloat16) * 0.05)(2 * F * F * D) * 0.01),
        "w_deep1": _w((lambda *s: torch.randn(*s, dtype=torch.bfloat16) * 0.8)(F * D, H) * ((F * D) ** -0.5)),
        "w_deep2": _w((lambda *s: torch.randn(*s, dtype=torch.bfloat16) * 0.05)(H) * 0.01),
    }

def reference(idx, table, se_w1, se_w2, w_bi, w_cross, w_deep1, w_deep2):
    emb = table[idx]
    B = emb.shape[0]
    z = emb.mean(axis=-1)
    a = _sigmoid(_gelu(z @ se_w1) @ se_w2)
    v = a[:, :, None] * emb
    eW = torch.einsum('bfd,de->bfe', emb, w_bi)
    vW = torch.einsum('bfd,de->bfe', v, w_bi)
    p = torch.einsum('bie,bje->bije', eW, emb).reshape(B, -1)
    q = torch.einsum('bie,bje->bije', vW, v).reshape(B, -1)
    cross_feat = torch.concatenate([p, q], axis=-1)
    logit_cross = cross_feat @ w_cross
    h = _gelu(emb.reshape(B, -1) @ w_deep1)
    logit_deep = h @ w_deep2
    return logit_cross + logit_deep
```

```asm
; @launch grid=(256,1,1) block=(512,1,1) lds=163840
.amdgcn_target "amdgcn-amd-amdhsa--gfx950"
.text
.globl standalone__deep_cross_fibinet__recsys_kernel
.p2align 8
.type standalone__deep_cross_fibinet__recsys_kernel,@function
standalone__deep_cross_fibinet__recsys_kernel:
    s_cmp_ge_u32 s2, 256
    s_cbranch_scc1 L_end
    s_load_dwordx16 s[60:75], s[0:1], 0
    s_load_dwordx4 s[76:79], s[0:1], 64
    s_load_dwordx2 s[44:45], s[0:1], 80
    v_lshrrev_b32 v2, 6, v0
    v_and_b32 v1, 63, v0
    s_getpc_b64 s[82:83]
    s_lshr_b32 s84, s2, 3
    s_mul_i32 s84, s84, 768
    v_lshlrev_b32 v3, 7, v0
    v_add_u32 v3, s84, v3
    v_min_u32 v3, CODE_END-standalone__deep_cross_fibinet__recsys_kernel-64, v3
    v_cmp_gt_u32 vcc, 6, v0
    s_and_saveexec_b64 s[84:85], vcc
    s_cbranch_execz L_nocpf
    global_load_dword v253, v3, s[82:83]
L_nocpf:
    s_mov_b64 exec, -1
    v_readfirstlane_b32 s48, v2
    v_mov_b32 v99, 163776
    v_mov_b32 v101, 0
    v_lshl_add_u32 v99, v1, 2, v99
    s_mov_b64 exec, 0xff
    ds_write_b32 v99, v101
    s_mov_b64 exec, -1
    s_mov_b32 s6, 425984
    s_mov_b32 s7, 0x20000
    s_mov_b32 s10, 128000
    s_mov_b32 s11, 0x20000
    s_mov_b32 s14, 676
    s_mov_b32 s15, 0x20000
    s_mov_b32 s18, 676
    s_mov_b32 s19, 0x20000
    s_mov_b32 s22, 8192
    s_mov_b32 s23, 0x20000
    s_mov_b32 s26, 173056
    s_mov_b32 s27, 0x20000
    s_mov_b32 s30, 851968
    s_mov_b32 s31, 0x20000
    s_mov_b32 s34, 512
    s_mov_b32 s35, 0x20000
    s_mov_b32 s38, 8192
    s_mov_b32 s39, 0x20000
    s_mov_b32 s42, 256
    s_mov_b32 s43, 0x20000
    s_mov_b32 s46, 268435456
    s_mov_b32 s47, 0x20000
    s_lshr_b32 s51, s2, 3
    s_and_b32 s55, s2, 7
    s_lshl_b32 s2, s55, 5
    s_add_u32 s2, s2, s51
    s_and_b32 s49, s2, 3
    s_lshr_b32 s50, s2, 2
    s_lshr_b32 s53, s2, 3
    s_and_b32 s54, s2, 7
    s_and_b32 s55, s50, 1
    s_lshl_b32 s52, s49, 1
    s_add_u32 s52, s52, s55
    s_mov_b32 s59, 0
    v_lshlrev_b32 v92, 4, v1
    v_and_b32 v99, 7, v1
    v_lshrrev_b32 v100, 4, v1
    v_xor_b32 v99, v99, v100
    v_lshlrev_b32 v99, 4, v99
    v_lshrrev_b32 v101, 3, v1
    v_lshl_or_b32 v93, v101, 7, v99
    v_lshlrev_b32 v137, 7, v1
    s_add_u32 s55, s48, 11
    s_cmp_eq_u32 s48, 4
    s_cselect_b32 s55, 31, s55
    s_cmp_lt_u32 s48, 4
    s_cselect_b32 s55, s48, s55
    s_cselect_b32 s56, 4, 3
    s_add_u32 s55, s55, s51
    s_and_b32 s94, s55, 31
    s_lshl_b32 s94, s94, 12
    s_min_u32 s94, s94, 123904
    s_add_u32 s55, s55, s56
    s_and_b32 s95, s55, 31
    s_lshl_b32 s95, s95, 12
    s_min_u32 s95, s95, 123904
    s_add_u32 s55, s55, s56
    s_and_b32 s96, s55, 31
    s_lshl_b32 s96, s96, 12
    s_min_u32 s96, s96, 123904
    s_add_u32 s55, s55, s56
    s_and_b32 s97, s55, 31
    s_lshl_b32 s97, s97, 12
    s_min_u32 s97, s97, 123904
    s_add_u32 s55, s55, s56
    s_and_b32 s85, s55, 31
    s_lshl_b32 s85, s85, 12
    s_min_u32 s85, s85, 123904
    s_add_u32 s55, s55, s56
    s_lshr_b32 s3, s94, 4
    s_and_b32 s3, s3, 64
    v_xor_b32 v94, s3, v93
    v_xor_b32 v95, 64, v94
    v_and_b32 v102, 15, v1
    v_lshrrev_b32 v101, 1, v102
    v_xor_b32 v101, v101, v100
    v_lshlrev_b32 v101, 4, v101
    v_lshl_or_b32 v96, v102, 7, v101
    v_lshrrev_b32 v6, 5, v1
    v_lshl_add_u32 v99, v6, 4, v102
    v_lshlrev_b32 v99, 1, v99
    v_add_u32 v98, 144000, v99
    v_bfe_u32 v97, v1, 4, 1
    v_add_lshl_u32 v97, v99, v97, 3
    v_add_u32 v97, 128000, v97
    v_lshrrev_b32 v101, 2, v102
    v_lshl_add_u32 v101, v100, 3, v101
    v_and_b32 v99, 1, v1
    v_lshl_add_u32 v101, v101, 1, v99
    v_lshlrev_b32 v101, 3, v101
    v_add_u32 v101, 159312, v101
    v_and_b32 v5, 31, v1
    v_lshl_add_u32 v7, v5, 1, v6
    v_mul_u32_u24 v7, 52, v7
    v_mov_b32 v103, 0x70
    s_mul_i32 s80, s53, 13312
    s_lshl_b32 s55, s48, 11
    s_add_u32 s81, s55, 146000
    s_add_u32 s80, s80, s55
    s_mov_b32 m0, s81
    s_lshl_b32 s81, s52, 4
    s_cmp_ge_u32 s48, 6
    s_waitcnt lgkmcnt(0)
    s_mov_b64 s[4:5], s[60:61]
    s_mov_b64 s[8:9], s[62:63]
    s_cbranch_scc1 L_stg67
    buffer_load_dwordx4 v92, s[4:7], s80 offen lds
    buffer_load_dwordx4 v92, s[4:7], s80 offen offset:1024 lds
    s_branch L_stgdone
L_stg67:
    s_mov_b64 s[12:13], s[64:65]
    s_mov_b64 s[16:17], s[66:67]
    s_mov_b64 s[20:21], s[68:69]
    s_cmp_eq_u32 s48, 7
    s_cbranch_scc1 L_stg7
    buffer_load_dwordx4 v92, s[4:7], s80 offen lds
    s_mov_b32 m0, 159312
    s_nop 0
    buffer_load_dwordx4 v137, s[20:23], s81 offen lds
    s_branch L_stgdone
L_stg7:
    s_mov_b32 m0, 160336
    s_nop 0
    buffer_load_dwordx4 v92, s[12:15], 0 offen lds
    s_mov_b32 m0, 161360
    s_nop 0
    buffer_load_dwordx4 v92, s[16:19], 0 offen lds
L_stgdone:
    s_mov_b32 m0, s94
    s_nop 0
    buffer_load_dwordx4 v94, s[8:11], s94 offen offset:0 lds
    buffer_load_dwordx4 v95, s[8:11], s94 offen offset:1024 lds
    buffer_load_dwordx4 v94, s[8:11], s94 offen offset:2048 lds
    buffer_load_dwordx4 v95, s[8:11], s94 offen offset:3072 lds
    s_mov_b64 s[24:25], s[70:71]
    s_mov_b64 s[28:29], s[72:73]
    s_mov_b64 s[32:33], s[74:75]
    s_mov_b64 s[36:37], s[76:77]
    s_mov_b64 s[40:41], s[78:79]
    s_cmp_ge_u32 s48, 4
    s_cbranch_scc1 L_cross
    s_and_b32 s55, s50, 1
    s_lshl_b32 s55, s55, 1
    s_lshr_b32 s56, s48, 1
    s_add_u32 s58, s55, s56
    s_xor_b32 s56, s56, 1
    s_add_u32 s55, s55, s56
    s_mul_i32 s58, s58, 3328
    s_mul_i32 s55, s55, 3328
    s_add_u32 s58, s58, 146000
    s_add_u32 s55, s55, 146000
    v_add_u32 v10, s55, v7
    v_add_u32 v9, s58, v7
    v_mul_u32_u24 v7, 832, v6
    v_bfe_u32 v8, v1, 4, 1
    v_lshl_add_u32 v7, v8, 2, v7
    v_bfe_u32 v8, v1, 3, 1
    v_add_u32 v7, v7, v8
    v_and_b32 v11, 7, v1
    v_lshlrev_b32 v11, 4, v11
    v_lshl_or_b32 v2, v7, 9, v11
    v_add_u32 v3, 4096, v2
    v_cmp_eq_u32 vcc, 0, v8
    v_mov_b32 v11, 0x03020706
    v_mov_b32 v4, 0x05040100
    v_cndmask_b32 v4, v11, v4, vcc
    s_lshr_b32 s101, s51, 2
    s_add_u32 s57, s48, s101
    s_and_b32 s57, s57, 3
    s_lshl_b32 s58, s57, 13
    s_lshl_b32 s55, s49, 7
    s_add_u32 s58, s58, s55
    s_lshl_b32 s57, s57, 5
    s_lshr_b32 s55, s2, 5
    s_mul_i32 s55, s55, 13
    s_lshr_b32 s55, s55, 3
    s_lshl_b32 s73, s55, 15
    s_add_u32 s73, s73, s58
    s_lshl_b32 s56, s55, 2
    v_add_u32 v167, s56, v9
    v_add_u32 v180, s56, v10
    s_add_u32 s55, s55, 1
    s_cmp_eq_u32 s55, 13
    s_cselect_b32 s55, 0, s55
    s_lshl_b32 s74, s55, 15
    s_add_u32 s74, s74, s58
    s_lshl_b32 s56, s55, 2
    v_add_u32 v168, s56, v9
    v_add_u32 v181, s56, v10
    s_add_u32 s55, s55, 1
    s_cmp_eq_u32 s55, 13
    s_cselect_b32 s55, 0, s55
    s_lshl_b32 s75, s55, 15
    s_add_u32 s75, s75, s58
    s_lshl_b32 s56, s55, 2
    v_add_u32 v169, s56, v9
    v_add_u32 v182, s56, v10
    s_add_u32 s55, s55, 1
    s_cmp_eq_u32 s55, 13
    s_cselect_b32 s55, 0, s55
    s_lshl_b32 s76, s55, 15
    s_add_u32 s76, s76, s58
    s_lshl_b32 s56, s55, 2
    v_add_u32 v170, s56, v9
    v_add_u32 v183, s56, v10
    s_add_u32 s55, s55, 1
    s_cmp_eq_u32 s55, 13
    s_cselect_b32 s55, 0, s55
    s_lshl_b32 s77, s55, 15
    s_add_u32 s77, s77, s58
    s_lshl_b32 s56, s55, 2
    v_add_u32 v171, s56, v9
    v_add_u32 v184, s56, v10
    s_add_u32 s55, s55, 1
    s_cmp_eq_u32 s55, 13
    s_cselect_b32 s55, 0, s55
    s_lshl_b32 s78, s55, 15
    s_add_u32 s78, s78, s58
    s_lshl_b32 s56, s55, 2
    v_add_u32 v172, s56, v9
    v_add_u32 v185, s56, v10
    s_add_u32 s55, s55, 1
    s_cmp_eq_u32 s55, 13
    s_cselect_b32 s55, 0, s55
    s_lshl_b32 s79, s55, 15
    s_add_u32 s79, s79, s58
    s_lshl_b32 s56, s55, 2
    v_add_u32 v173, s56, v9
    v_add_u32 v186, s56, v10
    s_add_u32 s55, s55, 1
    s_cmp_eq_u32 s55, 13
    s_cselect_b32 s55, 0, s55
    s_lshl_b32 s80, s55, 15
    s_add_u32 s80, s80, s58
    s_lshl_b32 s56, s55, 2
    v_add_u32 v174, s56, v9
    v_add_u32 v187, s56, v10
    s_add_u32 s55, s55, 1
    s_cmp_eq_u32 s55, 13
    s_cselect_b32 s55, 0, s55
    s_lshl_b32 s81, s55, 15
    s_add_u32 s81, s81, s58
    s_lshl_b32 s56, s55, 2
    v_add_u32 v175, s56, v9
    v_add_u32 v188, s56, v10
    s_add_u32 s55, s55, 1
    s_cmp_eq_u32 s55, 13
    s_cselect_b32 s55, 0, s55
    s_lshl_b32 s82, s55, 15
    s_add_u32 s82, s82, s58
    s_lshl_b32 s56, s55, 2
    v_add_u32 v176, s56, v9
    v_add_u32 v189, s56, v10
    s_add_u32 s55, s55, 1
    s_cmp_eq_u32 s55, 13
    s_cselect_b32 s55, 0, s55
    s_lshl_b32 s83, s55, 15
    s_add_u32 s83, s83, s58
    s_lshl_b32 s56, s55, 2
    v_add_u32 v177, s56, v9
    v_add_u32 v190, s56, v10
    s_add_u32 s55, s55, 1
    s_cmp_eq_u32 s55, 13
    s_cselect_b32 s55, 0, s55
    s_lshl_b32 s84, s55, 15
    s_add_u32 s84, s84, s58
    s_lshl_b32 s56, s55, 2
    v_add_u32 v178, s56, v9
    v_add_u32 v191, s56, v10
    s_add_u32 s55, s55, 1
    s_cmp_eq_u32 s55, 13
    s_cselect_b32 s55, 0, s55
    s_lshl_b32 s85, s55, 15
    s_add_u32 s85, s85, s58
    s_lshl_b32 s56, s55, 2
    v_add_u32 v179, s56, v9
    v_add_u32 v153, s56, v10
    s_lshr_b32 s3, s94, 4
    s_and_b32 s3, s3, 64
    v_xor_b32 v224, s3, v96
    v_add_u32 v224, s94, v224
    v_xor_b32 v228, 64, v224
    s_lshr_b32 s3, s94, 3
    v_add_u32 v232, s3, v97
    s_lshr_b32 s3, s94, 6
    v_add_u32 v236, s3, v98
    s_lshr_b32 s3, s95, 4
    s_and_b32 s3, s3, 64
    v_xor_b32 v225, s3, v96
    v_add_u32 v225, s95, v225
    v_xor_b32 v229, 64, v225
    v_xor_b32 v242, s3, v93
    v_xor_b32 v243, 64, v242
    s_lshr_b32 s3, s95, 3
    v_add_u32 v233, s3, v97
    s_lshr_b32 s3, s95, 6
    v_add_u32 v237, s3, v98
    s_lshr_b32 s3, s96, 4
    s_and_b32 s3, s3, 64
    v_xor_b32 v226, s3, v96
    v_add_u32 v226, s96, v226
    v_xor_b32 v230, 64, v226
    v_xor_b32 v244, s3, v93
    v_xor_b32 v245, 64, v244
    s_lshr_b32 s3, s96, 3
    v_add_u32 v234, s3, v97
    s_lshr_b32 s3, s96, 6
    v_add_u32 v238, s3, v98
    s_lshr_b32 s3, s97, 4
    s_and_b32 s3, s3, 64
    v_xor_b32 v227, s3, v96
    v_add_u32 v227, s97, v227
    v_xor_b32 v231, 64, v227
    v_xor_b32 v246, s3, v93
    v_xor_b32 v247, 64, v246
    s_lshr_b32 s3, s97, 3
    v_add_u32 v235, s3, v97
    s_lshr_b32 s3, s97, 6
    v_add_u32 v239, s3, v98
    v_cmp_gt_u32 s[98:99], 8, v102
    v_cmp_eq_u32 vcc, 8, v102
    v_mov_b32 v100, 0x3c803c80
    s_nop 0
    v_cndmask_b32 v100, 0, v100, vcc
    s_mov_b32 m0, s95
    s_nop 0
    buffer_load_dwordx4 v242, s[8:11], s95 offen offset:0 lds
    buffer_load_dwordx4 v243, s[8:11], s95 offen offset:1024 lds
    buffer_load_dwordx4 v242, s[8:11], s95 offen offset:2048 lds
    buffer_load_dwordx4 v243, s[8:11], s95 offen offset:3072 lds
    s_waitcnt vmcnt(8)
    s_barrier
    s_mov_b32 m0, s96
    s_nop 0
    buffer_load_dwordx4 v244, s[8:11], s96 offen offset:0 lds
    ds_read_b64_tr_b16 v[104:105], v101 offset:0
    ds_read_b64_tr_b16 v[106:107], v101 offset:64
    ds_read_b64_tr_b16 v[108:109], v101 offset:512
    ds_read_b64_tr_b16 v[110:111], v101 offset:576
    ds_read_b32 v140, v167
    ds_read_b32 v154, v180
    ds_read_b32 v141, v168
    ds_read_b32 v155, v181
    ds_read_b32 v142, v169
    ds_read_b32 v156, v182
    ds_read_b32 v143, v170
    ds_read_b32 v157, v183
    ds_read_b32 v144, v171
    ds_read_b32 v158, v184
    ds_read_b32 v145, v172
    ds_read_b32 v159, v185
    buffer_load_dwordx4 v245, s[8:11], s96 offen offset:1024 lds
    ds_read_b32 v146, v173
    ds_read_b32 v160, v186
    ds_read_b32 v147, v174
    ds_read_b32 v161, v187
    ds_read_b32 v148, v175
    ds_read_b32 v162, v188
    ds_read_b32 v149, v176
    ds_read_b32 v163, v189
    ds_read_b32 v150, v177
    ds_read_b32 v164, v190
    ds_read_b32 v151, v178
    ds_read_b32 v165, v191
    ds_read_b32 v152, v179
    ds_read_b32 v166, v153
    s_waitcnt lgkmcnt(15)
    v_cndmask_b32 v104, v100, v104, s[98:99]
    v_cndmask_b32 v105, v100, v105, s[98:99]
    v_cndmask_b32 v106, v100, v106, s[98:99]
    buffer_load_dwordx4 v244, s[8:11], s96 offen offset:2048 lds
    v_cndmask_b32 v107, v100, v107, s[98:99]
    v_cndmask_b32 v108, v100, v108, s[98:99]
    v_cndmask_b32 v109, v100, v109, s[98:99]
    v_cndmask_b32 v110, v100, v110, s[98:99]
    v_cndmask_b32 v111, v100, v111, s[98:99]
    s_waitcnt vmcnt(7)
    ds_read_b128 v[112:115], v224 offset:0
    ds_read_b128 v[116:119], v228 offset:0
    ds_read_b128 v[120:123], v224 offset:2048
    ds_read_b128 v[124:127], v228 offset:2048
    v_lshlrev_b32 v167, 3, v140
    v_bitop3_b32 v167, v167, s57, v103 bitop3:0x28
    v_lshl_or_b32 v167, v140, 7, v167
    v_xor_b32 v140, 16, v167
    v_lshlrev_b32 v180, 3, v154
    v_bitop3_b32 v180, v180, s57, v103 bitop3:0x28
    v_lshl_or_b32 v180, v154, 7, v180
    buffer_load_dwordx4 v245, s[8:11], s96 offen offset:3072 lds
    v_xor_b32 v154, 16, v180
    v_lshlrev_b32 v168, 3, v141
    v_bitop3_b32 v168, v168, s57, v103 bitop3:0x28
    v_lshl_or_b32 v168, v141, 7, v168
    v_xor_b32 v141, 16, v168
    v_lshlrev_b32 v181, 3, v155
    v_bitop3_b32 v181, v181, s57, v103 bitop3:0x28
    v_lshl_or_b32 v181, v155, 7, v181
    v_xor_b32 v155, 16, v181
    s_waitcnt lgkmcnt(3)
    v_mfma_f32_16x16x32_bf16 v[128:131], v[104:107], v[112:115], 0
    s_waitcnt lgkmcnt(1)
    v_mfma_f32_16x16x32_bf16 v[132:135], v[104:107], v[120:123], 0
    v_mfma_f32_16x16x32_bf16 v[128:131], v[108:111], v[116:119], v[128:131]
    s_waitcnt lgkmcnt(0)
    v_mfma_f32_16x16x32_bf16 v[132:135], v[108:111], v[124:127], v[132:135]
    v_lshlrev_b32 v169, 3, v142
    v_bitop3_b32 v169, v169, s57, v103 bitop3:0x28
    v_lshl_or_b32 v169, v142, 7, v169
    s_mov_b32 m0, s97
    s_nop 0
    buffer_load_dwordx4 v246, s[8:11], s97 offen offset:0 lds
    v_xor_b32 v142, 16, v169
    v_lshlrev_b32 v182, 3, v156
    v_bitop3_b32 v182, v182, s57, v103 bitop3:0x28
    v_lshl_or_b32 v182, v156, 7, v182
    v_xor_b32 v156, 16, v182
    v_lshlrev_b32 v170, 3, v143
    v_bitop3_b32 v170, v170, s57, v103 bitop3:0x28
    v_lshl_or_b32 v170, v143, 7, v170
    v_xor_b32 v143, 16, v170
    v_lshlrev_b32 v183, 3, v157
    v_bitop3_b32 v183, v183, s57, v103 bitop3:0x28
    v_lshl_or_b32 v183, v157, 7, v183
    v_xor_b32 v157, 16, v183
    v_cvt_pk_bf16_f32 v76, v128, v129
    v_cvt_pk_bf16_f32 v78, v132, v133
    v_cvt_pk_bf16_f32 v77, v130, v131
    buffer_load_dwordx4 v247, s[8:11], s97 offen offset:1024 lds
    v_cvt_pk_bf16_f32 v79, v134, v135
    v_permlane32_swap_b32 v76, v78
    s_nop 0
    v_permlane32_swap_b32 v77, v79
    s_waitcnt vmcnt(6)
    ds_read_b128 v[112:115], v225 offset:0
    ds_read_b128 v[116:119], v229 offset:0
    ds_read_b128 v[120:123], v225 offset:2048
    ds_read_b128 v[124:127], v229 offset:2048
    v_lshlrev_b32 v171, 3, v144
    v_bitop3_b32 v171, v171, s57, v103 bitop3:0x28
    v_lshl_or_b32 v171, v144, 7, v171
    v_xor_b32 v144, 16, v171
    v_lshlrev_b32 v184, 3, v158
    v_bitop3_b32 v184, v184, s57, v103 bitop3:0x28
    v_lshl_or_b32 v184, v158, 7, v184
    v_xor_b32 v158, 16, v184
    v_lshlrev_b32 v172, 3, v145
    buffer_load_dwordx4 v246, s[8:11], s97 offen offset:2048 lds
    v_bitop3_b32 v172, v172, s57, v103 bitop3:0x28
    v_lshl_or_b32 v172, v145, 7, v172
    v_xor_b32 v145, 16, v172
    v_lshlrev_b32 v185, 3, v159
    v_bitop3_b32 v185, v185, s57, v103 bitop3:0x28
    v_lshl_or_b32 v185, v159, 7, v185
    v_xor_b32 v159, 16, v185
    s_waitcnt lgkmcnt(3)
    v_mfma_f32_16x16x32_bf16 v[128:131], v[104:107], v[112:115], 0
    s_waitcnt lgkmcnt(1)
    v_mfma_f32_16x16x32_bf16 v[132:135], v[104:107], v[120:123], 0
    v_mfma_f32_16x16x32_bf16 v[128:131], v[108:111], v[116:119], v[128:131]
    s_waitcnt lgkmcnt(0)
    v_mfma_f32_16x16x32_bf16 v[132:135], v[108:111], v[124:127], v[132:135]
    v_lshlrev_b32 v173, 3, v146
    v_bitop3_b32 v173, v173, s57, v103 bitop3:0x28
    v_lshl_or_b32 v173, v146, 7, v173
    v_xor_b32 v146, 16, v173
    v_lshlrev_b32 v186, 3, v160
    v_bitop3_b32 v186, v186, s57, v103 bitop3:0x28
    buffer_load_dwordx4 v247, s[8:11], s97 offen offset:3072 lds
    v_lshl_or_b32 v186, v160, 7, v186
    v_xor_b32 v160, 16, v186
    v_lshlrev_b32 v174, 3, v147
    v_bitop3_b32 v174, v174, s57, v103 bitop3:0x28
    v_lshl_or_b32 v174, v147, 7, v174
    v_xor_b32 v147, 16, v174
    v_lshlrev_b32 v187, 3, v161
    v_bitop3_b32 v187, v187, s57, v103 bitop3:0x28
    v_lshl_or_b32 v187, v161, 7, v187
    v_xor_b32 v161, 16, v187
    v_cvt_pk_bf16_f32 v80, v128, v129
    v_cvt_pk_bf16_f32 v82, v132, v133
    v_cvt_pk_bf16_f32 v81, v130, v131
    v_cvt_pk_bf16_f32 v83, v134, v135
    v_permlane32_swap_b32 v80, v82
    s_nop 0
    v_permlane32_swap_b32 v81, v83
    buffer_load_dwordx4 v[12:15], v2, s[28:31], s73 offen offset:0
    s_waitcnt vmcnt(5)
    buffer_load_dwordx4 v[16:19], v2, s[28:31], s73 offen offset:1024
    ds_read_b128 v[112:115], v226 offset:0
    ds_read_b128 v[116:119], v230 offset:0
    buffer_load_dwordx4 v[20:23], v3, s[28:31], s73 offen offset:0
    ds_read_b128 v[120:123], v226 offset:2048
    buffer_load_dwordx4 v[24:27], v3, s[28:31], s73 offen offset:1024
    ds_read_b128 v[124:127], v230 offset:2048
    buffer_load_dwordx4 v[28:31], v2, s[28:31], s74 offen offset:0
    s_mov_b32 exec_lo, 0xffff
    s_mov_b32 exec_hi, 0xffff
    ds_write_b16 v236, v78
    ds_write_b16 v237, v82
    s_mov_b64 exec, -1
    buffer_load_dwordx4 v[32:35], v2, s[28:31], s74 offen offset:1024
    ds_write_b64 v232, v[76:77]
    ds_write_b64 v233, v[80:81]
    buffer_load_dwordx4 v[36:39], v3, s[28:31], s74 offen offset:0
    s_waitcnt lgkmcnt(7)
    v_mfma_f32_16x16x32_bf16 v[128:131], v[104:107], v[112:115], 0
    buffer_load_dwordx4 v[40:43], v3, s[28:31], s74 offen offset:1024
    s_waitcnt lgkmcnt(5)
    v_mfma_f32_16x16x32_bf16 v[132:135], v[104:107], v[120:123], 0
    buffer_load_dwordx4 v[44:47], v2, s[28:31], s75 offen offset:0
    v_mfma_f32_16x16x32_bf16 v[128:131], v[108:111], v[116:119], v[128:131]
    s_waitcnt lgkmcnt(4)
    v_mfma_f32_16x16x32_bf16 v[132:135], v[108:111], v[124:127], v[132:135]
    buffer_load_dwordx4 v[48:51], v2, s[28:31], s75 offen offset:1024
    s_nop 4
    v_cvt_pk_bf16_f32 v84, v128, v129
    buffer_load_dwordx4 v[52:55], v3, s[28:31], s75 offen offset:0
    v_cvt_pk_bf16_f32 v86, v132, v133
    buffer_load_dwordx4 v[56:59], v3, s[28:31], s75 offen offset:1024
    v_cvt_pk_bf16_f32 v85, v130, v131
    buffer_load_dwordx4 v[60:63], v2, s[28:31], s76 offen offset:0
    v_cvt_pk_bf16_f32 v87, v134, v135
    v_permlane32_swap_b32 v84, v86
    buffer_load_dwordx4 v[64:67], v2, s[28:31], s76 offen offset:1024
    v_permlane32_swap_b32 v85, v87
    s_waitcnt vmcnt(14)
    ds_read_b128 v[112:115], v227 offset:0
    ds_read_b128 v[116:119], v231 offset:0
    ds_read_b128 v[120:123], v227 offset:2048
    ds_read_b128 v[124:127], v231 offset:2048
    s_mov_b32 exec_lo, 0xffff
    s_mov_b32 exec_hi, 0xffff
    ds_write_b16 v238, v86
    s_mov_b64 exec, -1
    ds_write_b64 v234, v[84:85]
    s_waitcnt lgkmcnt(5)
    v_mfma_f32_16x16x32_bf16 v[128:131], v[104:107], v[112:115], 0
    s_waitcnt lgkmcnt(3)
    v_mfma_f32_16x16x32_bf16 v[132:135], v[104:107], v[120:123], 0
    v_mfma_f32_16x16x32_bf16 v[128:131], v[108:111], v[116:119], v[128:131]
    s_waitcnt lgkmcnt(2)
    v_mfma_f32_16x16x32_bf16 v[132:135], v[108:111], v[124:127], v[132:135]
    s_nop 5
    v_cvt_pk_bf16_f32 v88, v128, v129
    s_nop 0
    v_cvt_pk_bf16_f32 v90, v132, v133
    v_cvt_pk_bf16_f32 v89, v130, v131
    v_cvt_pk_bf16_f32 v91, v134, v135
    v_permlane32_swap_b32 v88, v90
    s_nop 0
    v_permlane32_swap_b32 v89, v91
    s_mov_b32 exec_lo, 0xffff
    s_mov_b32 exec_hi, 0xffff
    ds_write_b16 v239, v90
    s_mov_b64 exec, -1
    ds_write_b64 v235, v[88:89]
    s_waitcnt lgkmcnt(0)
    s_barrier
    v_mov_b32 v0, 163776
    v_mov_b32 v10, 1
    v_mov_b32 v11, 0x70
    v_lshlrev_b32 v5, 7, v1
    s_lshl_b32 s58, s52, 4
    ds_read_b128 v[116:119], v167
    ds_read_b128 v[120:123], v180
    ds_read_b128 v[124:127], v140
    ds_read_b128 v[128:131], v154
    buffer_load_dwordx4 v[68:71], v3, s[28:31], s76 offen offset:0
    buffer_load_dwordx4 v[72:75], v3, s[28:31], s76 offen offset:1024
    s_waitcnt vmcnt(14)
    v_mov_b32_dpp v92, v12 row_ror:8 row_mask:0xf bank_mask:0xf bound_ctrl:0
    v_mov_b32_dpp v94, v14 row_ror:8 row_mask:0xf bank_mask:0xf bound_ctrl:0
    v_mov_b32_dpp v93, v13 row_ror:8 row_mask:0xf bank_mask:0xf bound_ctrl:0
    v_mov_b32_dpp v95, v15 row_ror:8 row_mask:0xf bank_mask:0xf bound_ctrl:0
    v_perm_b32 v100, v92, v12, v4
    v_perm_b32 v102, v94, v14, v4
    v_mov_b32_dpp v96, v16 row_ror:8 row_mask:0xf bank_mask:0xf bound_ctrl:0
    v_mov_b32_dpp v98, v18 row_ror:8 row_mask:0xf bank_mask:0xf bound_ctrl:0
    v_perm_b32 v104, v93, v13, v4
    v_perm_b32 v106, v95, v15, v4
    v_permlane16_swap_b32 v100, v102
    v_mov_b32_dpp v97, v17 row_ror:8 row_mask:0xf bank_mask:0xf bound_ctrl:0
    v_mov_b32_dpp v99, v19 row_ror:8 row_mask:0xf bank_mask:0xf bound_ctrl:0
    v_perm_b32 v101, v96, v16, v4
    v_perm_b32 v103, v98, v18, v4
    v_perm_b32 v105, v97, v17, v4
    v_perm_b32 v107, v99, v19, v4
    v_permlane16_swap_b32 v104, v106
    v_permlane16_swap_b32 v101, v103
    v_permlane16_swap_b32 v105, v107
    s_waitcnt vmcnt(12) lgkmcnt(2)
    v_mfma_f32_32x32x16_bf16 v[192:207], v[100:103], v[116:119], 0
    buffer_load_dwordx4 v[76:79], v2, s[28:31], s77 offen offset:0
    v_mov_b32_dpp v92, v20 row_ror:8 row_mask:0xf bank_mask:0xf bound_ctrl:0
    v_mov_b32_dpp v94, v22 row_ror:8 row_mask:0xf bank_mask:0xf bound_ctrl:0
    v_mov_b32_dpp v93, v21 row_ror:8 row_mask:0xf bank_mask:0xf bound_ctrl:0
    v_mov_b32_dpp v95, v23 row_ror:8 row_mask:0xf bank_mask:0xf bound_ctrl:0
    v_perm_b32 v108, v92, v20, v4
    v_perm_b32 v110, v94, v22, v4
    v_lshlrev_b32 v175, 3, v148
    v_bitop3_b32 v175, v175, s57, v11 bitop3:0x28
    v_mfma_f32_32x32x16_bf16 v[208:223], v[100:103], v[120:123], 0
    buffer_load_dwordx4 v[80:83], v2, s[28:31], s77 offen offset:1024
    v_mov_b32_dpp v96, v24 row_ror:8 row_mask:0xf bank_mask:0xf bound_ctrl:0
    v_mov_b32_dpp v98, v26 row_ror:8 row_mask:0xf bank_mask:0xf bound_ctrl:0
    v_perm_b32 v112, v93, v21, v4
    v_perm_b32 v114, v95, v23, v4
    v_permlane16_swap_b32 v108, v110
    v_lshl_or_b32 v175, v148, 7, v175
    v_xor_b32 v148, 16, v175
    v_mfma_f32_32x32x16_bf16 v[224:239], v[104:107], v[116:119], 0
    buffer_load_dwordx4 v[84:87], v3, s[28:31], s77 offen offset:0
    ds_read_b128 v[132:135], v168
    v_mov_b32_dpp v97, v25 row_ror:8 row_mask:0xf bank_mask:0xf bound_ctrl:0
    v_mov_b32_dpp v99, v27 row_ror:8 row_mask:0xf bank_mask:0xf bound_ctrl:0
    v_perm_b32 v109, v96, v24, v4
    v_perm_b32 v111, v98, v26, v4
    v_perm_b32 v113, v97, v25, v4
    v_lshlrev_b32 v188, 3, v162
    v_bitop3_b32 v188, v188, s57, v11 bitop3:0x28
    v_mfma_f32_32x32x16_bf16 v[240:255], v[104:107], v[120:123], 0
    buffer_load_dwordx4 v[88:91], v3, s[28:31], s77 offen offset:1024
    ds_read_b128 v[136:139], v181
    v_perm_b32 v115, v99, v27, v4
    v_permlane16_swap_b32 v112, v114
    v_permlane16_swap_b32 v109, v111
    v_permlane16_swap_b32 v113, v115
    v_lshl_or_b32 v188, v162, 7, v188
    v_xor_b32 v162, 16, v188
    s_add_u32 s55, s48, 0
    s_lshl_b32 s56, s55, 10
    s_add_u32 m0, s56, 146000
    s_lshl_b32 s55, s55, 13
    s_add_u32 s55, s55, s58
    s_add_u32 s55, s55, 86528
    buffer_load_dwordx4 v5, s[24:27], s55 offen lds
    s_waitcnt vmcnt(15) lgkmcnt(2)
    v_mfma_f32_32x32x16_bf16 v[192:207], v[108:111], v[124:127], v[192:207]
    buffer_load_dwordx4 v[12:15], v2, s[28:31], s78 offen offset:0
    v_mov_b32_dpp v92, v28 row_ror:8 row_mask:0xf bank_mask:0xf bound_ctrl:0
    v_mov_b32_dpp v94, v30 row_ror:8 row_mask:0xf bank_mask:0xf bound_ctrl:0
    v_mov_b32_dpp v93, v29 row_ror:8 row_mask:0xf bank_mask:0xf bound_ctrl:0
    v_mov_b32_dpp v95, v31 row_ror:8 row_mask:0xf bank_mask:0xf bound_ctrl:0
    v_perm_b32 v100, v92, v28, v4
    v_perm_b32 v102, v94, v30, v4
    v_lshlrev_b32 v176, 3, v149
    v_bitop3_b32 v176, v176, s57, v11 bitop3:0x28
    v_mfma_f32_32x32x16_bf16 v[208:223], v[108:111], v[128:131], v[208:223]
    buffer_load_dwordx4 v[16:19], v2, s[28:31], s78 offen offset:1024
    v_mov_b32_dpp v96, v32 row_ror:8 row_mask:0xf bank_mask:0xf bound_ctrl:0
    v_mov_b32_dpp v98, v34 row_ror:8 row_mask:0xf bank_mask:0xf bound_ctrl:0
    v_perm_b32 v104, v93, v29, v4
    v_perm_b32 v106, v95, v31, v4
    v_permlane16_swap_b32 v100, v102
    v_lshl_or_b32 v176, v149, 7, v176
    v_xor_b32 v149, 16, v176
    v_mfma_f32_32x32x16_bf16 v[224:239], v[112:115], v[124:127], v[224:239]
    buffer_load_dwordx4 v[20:23], v3, s[28:31], s78 offen offset:0
    ds_read_b128 v[116:119], v141
    v_mov_b32_dpp v97, v33 row_ror:8 row_mask:0xf bank_mask:0xf bound_ctrl:0
    v_mov_b32_dpp v99, v35 row_ror:8 row_mask:0xf bank_mask:0xf bound_ctrl:0
    v_perm_b32 v101, v96, v32, v4
    v_perm_b32 v103, v98, v34, v4
    v_perm_b32 v105, v97, v33, v4
    v_lshlrev_b32 v189, 3, v163
    v_bitop3_b32 v189, v189, s57, v11 bitop3:0x28
    v_mfma_f32_32x32x16_bf16 v[240:255], v[112:115], v[128:131], v[240:255]
    buffer_load_dwordx4 v[24:27], v3, s[28:31], s78 offen offset:1024
    ds_read_b128 v[120:123], v155
    v_perm_b32 v107, v99, v35, v4
    v_permlane16_swap_b32 v104, v106
    v_permlane16_swap_b32 v101, v103
    v_permlane16_swap_b32 v105, v107
    v_lshl_or_b32 v189, v163, 7, v189
    v_xor_b32 v163, 16, v189
    s_waitcnt vmcnt(17) lgkmcnt(2)
    v_mfma_f32_32x32x16_bf16 v[192:207], v[100:103], v[132:135], v[192:207]
    buffer_load_dwordx4 v[28:31], v2, s[28:31], s79 offen offset:0
    v_mov_b32_dpp v92, v36 row_ror:8 row_mask:0xf bank_mask:0xf bound_ctrl:0
    v_mov_b32_dpp v94, v38 row_ror:8 row_mask:0xf bank_mask:0xf bound_ctrl:0
    v_mov_b32_dpp v93, v37 row_ror:8 row_mask:0xf bank_mask:0xf bound_ctrl:0
    v_mov_b32_dpp v95, v39 row_ror:8 row_mask:0xf bank_mask:0xf bound_ctrl:0
    v_perm_b32 v108, v92, v36, v4
    v_perm_b32 v110, v94, v38, v4
    v_lshlrev_b32 v177, 3, v150
    v_bitop3_b32 v177, v177, s57, v11 bitop3:0x28
    v_mfma_f32_32x32x16_bf16 v[208:223], v[100:103], v[136:139], v[208:223]
    buffer_load_dwordx4 v[32:35], v2, s[28:31], s79 offen offset:1024
    v_mov_b32_dpp v96, v40 row_ror:8 row_mask:0xf bank_mask:0xf bound_ctrl:0
    v_mov_b32_dpp v98, v42 row_ror:8 row_mask:0xf bank_mask:0xf bound_ctrl:0
    v_perm_b32 v112, v93, v37, v4
    v_perm_b32 v114, v95, v39, v4
    v_permlane16_swap_b32 v108, v110
    v_lshl_or_b32 v177, v150, 7, v177
    v_xor_b32 v150, 16, v177
    v_mfma_f32_32x32x16_bf16 v[224:239], v[104:107], v[132:135], v[224:239]
    ds_read_b128 v[124:127], v169
    v_mov_b32_dpp v97, v41 row_ror:8 row_mask:0xf bank_mask:0xf bound_ctrl:0
    v_mov_b32_dpp v99, v43 row_ror:8 row_mask:0xf bank_mask:0xf bound_ctrl:0
    v_perm_b32 v109, v96, v40, v4
    v_perm_b32 v111, v98, v42, v4
    v_perm_b32 v113, v97, v41, v4
    v_lshlrev_b32 v190, 3, v164
    v_bitop3_b32 v190, v190, s57, v11 bitop3:0x28
    v_mfma_f32_32x32x16_bf16 v[240:255], v[104:107], v[136:139], v[240:255]
    ds_read_b128 v[128:131], v182
    v_perm_b32 v115, v99, v43, v4
    v_permlane16_swap_b32 v112, v114
    v_permlane16_swap_b32 v109, v111
    v_permlane16_swap_b32 v113, v115
    v_lshl_or_b32 v190, v164, 7, v190
    v_xor_b32 v164, 16, v190
    s_add_u32 s55, s48, 4
    s_lshl_b32 s56, s55, 10
    s_add_u32 m0, s56, 146000
    s_lshl_b32 s55, s55, 13
    s_add_u32 s55, s55, s58
    s_add_u32 s55, s55, 86528
    buffer_load_dwordx4 v5, s[24:27], s55 offen lds
    s_waitcnt vmcnt(18) lgkmcnt(2)
    v_mfma_f32_32x32x16_bf16 v[192:207], v[108:111], v[116:119], v[192:207]
    buffer_load_dwordx4 v[36:39], v3, s[28:31], s79 offen offset:0
    v_mov_b32_dpp v92, v44 row_ror:8 row_mask:0xf bank_mask:0xf bound_ctrl:0
    v_mov_b32_dpp v94, v46 row_ror:8 row_mask:0xf bank_mask:0xf bound_ctrl:0
    v_mov_b32_dpp v93, v45 row_ror:8 row_mask:0xf bank_mask:0xf bound_ctrl:0
    v_mov_b32_dpp v95, v47 row_ror:8 row_mask:0xf bank_mask:0xf bound_ctrl:0
    v_perm_b32 v100, v92, v44, v4
    v_perm_b32 v102, v94, v46, v4
    v_lshlrev_b32 v178, 3, v151
    v_bitop3_b32 v178, v178, s57, v11 bitop3:0x28
    v_mfma_f32_32x32x16_bf16 v[208:223], v[108:111], v[120:123], v[208:223]
    buffer_load_dwordx4 v[40:43], v3, s[28:31], s79 offen offset:1024
    v_mov_b32_dpp v96, v48 row_ror:8 row_mask:0xf bank_mask:0xf bound_ctrl:0
    v_mov_b32_dpp v98, v50 row_ror:8 row_mask:0xf bank_mask:0xf bound_ctrl:0
    v_perm_b32 v104, v93, v45, v4
    v_perm_b32 v106, v95, v47, v4
    v_permlane16_swap_b32 v100, v102
    v_lshl_or_b32 v178, v151, 7, v178
    v_xor_b32 v151, 16, v178
    v_mfma_f32_32x32x16_bf16 v[224:239], v[112:115], v[116:119], v[224:239]
    ds_read_b128 v[132:135], v142
    v_mov_b32_dpp v97, v49 row_ror:8 row_mask:0xf bank_mask:0xf bound_ctrl:0
    v_mov_b32_dpp v99, v51 row_ror:8 row_mask:0xf bank_mask:0xf bound_ctrl:0
    v_perm_b32 v101, v96, v48, v4
    v_perm_b32 v103, v98, v50, v4
    v_perm_b32 v105, v97, v49, v4
    v_lshlrev_b32 v191, 3, v165
    v_bitop3_b32 v191, v191, s57, v11 bitop3:0x28
    v_mfma_f32_32x32x16_bf16 v[240:255], v[112:115], v[120:123], v[240:255]
    ds_read_b128 v[136:139], v156
    v_perm_b32 v107, v99, v51, v4
    v_permlane16_swap_b32 v104, v106
    v_permlane16_swap_b32 v101, v103
    v_permlane16_swap_b32 v105, v107
    v_lshl_or_b32 v191, v165, 7, v191
    v_xor_b32 v165, 16, v191
    s_waitcnt vmcnt(18) lgkmcnt(2)
    v_mfma_f32_32x32x16_bf16 v[192:207], v[100:103], v[124:127], v[192:207]
    buffer_load_dwordx4 v[44:47], v2, s[28:31], s80 offen offset:0
    v_mov_b32_dpp v92, v52 row_ror:8 row_mask:0xf bank_mask:0xf bound_ctrl:0
    v_mov_b32_dpp v94, v54 row_ror:8 row_mask:0xf bank_mask:0xf bound_ctrl:0
    v_mov_b32_dpp v93, v53 row_ror:8 row_mask:0xf bank_mask:0xf bound_ctrl:0
    v_mov_b32_dpp v95, v55 row_ror:8 row_mask:0xf bank_mask:0xf bound_ctrl:0
    v_perm_b32 v108, v92, v52, v4
    v_perm_b32 v110, v94, v54, v4
    v_lshlrev_b32 v179, 3, v152
    v_bitop3_b32 v179, v179, s57, v11 bitop3:0x28
    v_mfma_f32_32x32x16_bf16 v[208:223], v[100:103], v[128:131], v[208:223]
    buffer_load_dwordx4 v[48:51], v2, s[28:31], s80 offen offset:1024
    v_mov_b32_dpp v96, v56 row_ror:8 row_mask:0xf bank_mask:0xf bound_ctrl:0
    v_mov_b32_dpp v98, v58 row_ror:8 row_mask:0xf bank_mask:0xf bound_ctrl:0
    v_perm_b32 v112, v93, v53, v4
    v_perm_b32 v114, v95, v55, v4
    v_permlane16_swap_b32 v108, v110
    v_lshl_or_b32 v179, v152, 7, v179
    v_xor_b32 v152, 16, v179
    v_mfma_f32_32x32x16_bf16 v[224:239], v[104:107], v[124:127], v[224:239]
    ds_read_b128 v[116:119], v170
    v_mov_b32_dpp v97, v57 row_ror:8 row_mask:0xf bank_mask:0xf bound_ctrl:0
    v_mov_b32_dpp v99, v59 row_ror:8 row_mask:0xf bank_mask:0xf bound_ctrl:0
    v_perm_b32 v109, v96, v56, v4
    v_perm_b32 v111, v98, v58, v4
    v_perm_b32 v113, v97, v57, v4
    v_lshlrev_b32 v153, 3, v166
    v_bitop3_b32 v153, v153, s57, v11 bitop3:0x28
    v_mfma_f32_32x32x16_bf16 v[240:255], v[104:107], v[128:131], v[240:255]
    ds_read_b128 v[120:123], v183
    v_perm_b32 v115, v99, v59, v4
    v_permlane16_swap_b32 v112, v114
    v_permlane16_swap_b32 v109, v111
    v_permlane16_swap_b32 v113, v115
    v_lshl_or_b32 v153, v166, 7, v153
    v_xor_b32 v166, 16, v153
    s_add_u32 s55, s48, 8
    s_cmp_eq_u32 s55, 10
    s_cselect_b32 exec_lo, 0xffffffff, -1
    s_cselect_b32 exec_hi, 0xf, -1
    s_cmp_gt_u32 s55, 10
    s_cselect_b32 exec_lo, 1, exec_lo
    s_cselect_b32 exec_hi, 0, exec_hi
    s_min_u32 s55, s55, 10
    s_lshl_b32 s56, s55, 10
    s_add_u32 m0, s56, 146000
    s_lshl_b32 s55, s55, 13
    s_add_u32 s55, s55, s58
    s_add_u32 s55, s55, 86528
    buffer_load_dwordx4 v5, s[24:27], s55 offen lds
    s_mov_b64 exec, -1
    s_waitcnt vmcnt(19) lgkmcnt(2)
    v_mfma_f32_32x32x16_bf16 v[192:207], v[108:111], v[132:135], v[192:207]
    buffer_load_dwordx4 v[52:55], v3, s[28:31], s80 offen offset:0
    v_mov_b32_dpp v92, v60 row_ror:8 row_mask:0xf bank_mask:0xf bound_ctrl:0
    v_mov_b32_dpp v94, v62 row_ror:8 row_mask:0xf bank_mask:0xf bound_ctrl:0
    v_mov_b32_dpp v93, v61 row_ror:8 row_mask:0xf bank_mask:0xf bound_ctrl:0
    v_mov_b32_dpp v95, v63 row_ror:8 row_mask:0xf bank_mask:0xf bound_ctrl:0
    v_perm_b32 v100, v92, v60, v4
    v_perm_b32 v102, v94, v62, v4
    v_mfma_f32_32x32x16_bf16 v[208:223], v[108:111], v[136:139], v[208:223]
    buffer_load_dwordx4 v[56:59], v3, s[28:31], s80 offen offset:1024
    v_mov_b32_dpp v96, v64 row_ror:8 row_mask:0xf bank_mask:0xf bound_ctrl:0
    v_mov_b32_dpp v98, v66 row_ror:8 row_mask:0xf bank_mask:0xf bound_ctrl:0
    v_perm_b32 v104, v93, v61, v4
    v_perm_b32 v106, v95, v63, v4
    v_permlane16_swap_b32 v100, v102
    v_mfma_f32_32x32x16_bf16 v[224:239], v[112:115], v[132:135], v[224:239]
    ds_read_b128 v[124:127], v143
    v_mov_b32_dpp v97, v65 row_ror:8 row_mask:0xf bank_mask:0xf bound_ctrl:0
    v_mov_b32_dpp v99, v67 row_ror:8 row_mask:0xf bank_mask:0xf bound_ctrl:0
    v_perm_b32 v101, v96, v64, v4
    v_perm_b32 v103, v98, v66, v4
    v_perm_b32 v105, v97, v65, v4
    v_mfma_f32_32x32x16_bf16 v[240:255], v[112:115], v[136:139], v[240:255]
    ds_read_b128 v[128:131], v157
    v_perm_b32 v107, v99, v67, v4
    v_permlane16_swap_b32 v104, v106
    v_permlane16_swap_b32 v101, v103
    v_permlane16_swap_b32 v105, v107
    s_waitcnt vmcnt(19) lgkmcnt(2)
    v_mfma_f32_32x32x16_bf16 v[192:207], v[100:103], v[116:119], v[192:207]
    buffer_load_dwordx4 v[60:63], v2, s[28:31], s81 offen offset:0
    v_mov_b32_dpp v92, v68 row_ror:8 row_mask:0xf bank_mask:0xf bound_ctrl:0
    v_mov_b32_dpp v94, v70 row_ror:8 row_mask:0xf bank_mask:0xf bound_ctrl:0
    v_mov_b32_dpp v93, v69 row_ror:8 row_mask:0xf bank_mask:0xf bound_ctrl:0
    v_mov_b32_dpp v95, v71 row_ror:8 row_mask:0xf bank_mask:0xf bound_ctrl:0
    v_perm_b32 v108, v92, v68, v4
    v_perm_b32 v110, v94, v70, v4
    v_mfma_f32_32x32x16_bf16 v[208:223], v[100:103], v[120:123], v[208:223]
    buffer_load_dwordx4 v[64:67], v2, s[28:31], s81 offen offset:1024
    v_mov_b32_dpp v96, v72 row_ror:8 row_mask:0xf bank_mask:0xf bound_ctrl:0
    v_mov_b32_dpp v98, v74 row_ror:8 row_mask:0xf bank_mask:0xf bound_ctrl:0
    v_perm_b32 v112, v93, v69, v4
    v_perm_b32 v114, v95, v71, v4
    v_permlane16_swap_b32 v108, v110
    v_mfma_f32_32x32x16_bf16 v[224:239], v[104:107], v[116:119], v[224:239]
    ds_read_b128 v[132:135], v171
    v_mov_b32_dpp v97, v73 row_ror:8 row_mask:0xf bank_mask:0xf bound_ctrl:0
    v_mov_b32_dpp v99, v75 row_ror:8 row_mask:0xf bank_mask:0xf bound_ctrl:0
    v_perm_b32 v109, v96, v72, v4
    v_perm_b32 v111, v98, v74, v4
    v_perm_b32 v113, v97, v73, v4
    v_mfma_f32_32x32x16_bf16 v[240:255], v[104:107], v[120:123], v[240:255]
    ds_read_b128 v[136:139], v184
    v_perm_b32 v115, v99, v75, v4
    v_permlane16_swap_b32 v112, v114
    v_permlane16_swap_b32 v109, v111
    v_permlane16_swap_b32 v113, v115
    s_waitcnt vmcnt(19) lgkmcnt(2)
    v_mfma_f32_32x32x16_bf16 v[192:207], v[108:111], v[124:127], v[192:207]
    buffer_load_dwordx4 v[68:71], v3, s[28:31], s81 offen offset:0
    v_mov_b32_dpp v92, v76 row_ror:8 row_mask:0xf bank_mask:0xf bound_ctrl:0
    v_mov_b32_dpp v94, v78 row_ror:8 row_mask:0xf bank_mask:0xf bound_ctrl:0
    v_mov_b32_dpp v93, v77 row_ror:8 row_mask:0xf bank_mask:0xf bound_ctrl:0
    v_mov_b32_dpp v95, v79 row_ror:8 row_mask:0xf bank_mask:0xf bound_ctrl:0
    v_perm_b32 v100, v92, v76, v4
    v_perm_b32 v102, v94, v78, v4
    v_mfma_f32_32x32x16_bf16 v[208:223], v[108:111], v[128:131], v[208:223]
    buffer_load_dwordx4 v[72:75], v3, s[28:31], s81 offen offset:1024
    v_mov_b32_dpp v96, v80 row_ror:8 row_mask:0xf bank_mask:0xf bound_ctrl:0
    v_mov_b32_dpp v98, v82 row_ror:8 row_mask:0xf bank_mask:0xf bound_ctrl:0
    v_perm_b32 v104, v93, v77, v4
    v_perm_b32 v106, v95, v79, v4
    v_permlane16_swap_b32 v100, v102
    v_mfma_f32_32x32x16_bf16 v[224:239], v[112:115], v[124:127], v[224:239]
    ds_read_b128 v[116:119], v144
    v_mov_b32_dpp v97, v81 row_ror:8 row_mask:0xf bank_mask:0xf bound_ctrl:0
    v_mov_b32_dpp v99, v83 row_ror:8 row_mask:0xf bank_mask:0xf bound_ctrl:0
    v_perm_b32 v101, v96, v80, v4
    v_perm_b32 v103, v98, v82, v4
    v_perm_b32 v105, v97, v81, v4
    v_mfma_f32_32x32x16_bf16 v[240:255], v[112:115], v[128:131], v[240:255]
    ds_read_b128 v[120:123], v158
    v_perm_b32 v107, v99, v83, v4
    v_permlane16_swap_b32 v104, v106
    v_permlane16_swap_b32 v101, v103
    v_permlane16_swap_b32 v105, v107
    s_waitcnt vmcnt(6)
    s_mov_b64 exec, 1
    ds_add_u32 v0, v10 offset:0
    s_mov_b64 exec, -1
    s_waitcnt lgkmcnt(3)
    v_mfma_f32_32x32x16_bf16 v[192:207], v[100:103], v[132:135], v[192:207]
    buffer_load_dwordx4 v[76:79], v2, s[28:31], s82 offen offset:0
    v_mov_b32_dpp v92, v84 row_ror:8 row_mask:0xf bank_mask:0xf bound_ctrl:0
    v_mov_b32_dpp v94, v86 row_ror:8 row_mask:0xf bank_mask:0xf bound_ctrl:0
    v_mov_b32_dpp v93, v85 row_ror:8 row_mask:0xf bank_mask:0xf bound_ctrl:0
    v_mov_b32_dpp v95, v87 row_ror:8 row_mask:0xf bank_mask:0xf bound_ctrl:0
    v_perm_b32 v108, v92, v84, v4
    v_perm_b32 v110, v94, v86, v4
    v_mfma_f32_32x32x16_bf16 v[208:223], v[100:103], v[136:139], v[208:223]
    buffer_load_dwordx4 v[80:83], v2, s[28:31], s82 offen offset:1024
    v_mov_b32_dpp v96, v88 row_ror:8 row_mask:0xf bank_mask:0xf bound_ctrl:0
    v_mov_b32_dpp v98, v90 row_ror:8 row_mask:0xf bank_mask:0xf bound_ctrl:0
    v_perm_b32 v112, v93, v85, v4
    v_perm_b32 v114, v95, v87, v4
    v_permlane16_swap_b32 v108, v110
    v_mfma_f32_32x32x16_bf16 v[224:239], v[104:107], v[132:135], v[224:239]
    ds_read_b128 v[124:127], v172
    v_mov_b32_dpp v97, v89 row_ror:8 row_mask:0xf bank_mask:0xf bound_ctrl:0
    v_mov_b32_dpp v99, v91 row_ror:8 row_mask:0xf bank_mask:0xf bound_ctrl:0
    v_perm_b32 v109, v96, v88, v4
    v_perm_b32 v111, v98, v90, v4
    v_perm_b32 v113, v97, v89, v4
    v_mfma_f32_32x32x16_bf16 v[240:255], v[104:107], v[136:139], v[240:255]
    ds_read_b128 v[128:131], v185
    v_perm_b32 v115, v99, v91, v4
    v_permlane16_swap_b32 v112, v114
    v_permlane16_swap_b32 v109, v111
    v_permlane16_swap_b32 v113, v115
    s_add_u32 s55, s48, 0
    s_lshl_b32 s56, s55, 10
    s_add_u32 m0, s56, 157264
    s_lshl_b32 s55, s55, 13
    s_add_u32 s55, s55, s58
    s_add_u32 s55, s55, 0
    buffer_load_dwordx4 v5, s[24:27], s55 offen lds
    s_waitcnt lgkmcnt(3)
    v_mfma_f32_32x32x16_bf16 v[192:207], v[108:111], v[116:119], v[192:207]
    buffer_load_dwordx4 v[84:87], v3, s[28:31], s82 offen offset:0
    v_mov_b32_dpp v92, v12 row_ror:8 row_mask:0xf bank_mask:0xf bound_ctrl:0
    v_mov_b32_dpp v94, v14 row_ror:8 row_mask:0xf bank_mask:0xf bound_ctrl:0
    v_mov_b32_dpp v93, v13 row_ror:8 row_mask:0xf bank_mask:0xf bound_ctrl:0
    v_mov_b32_dpp v95, v15 row_ror:8 row_mask:0xf bank_mask:0xf bound_ctrl:0
    v_perm_b32 v100, v92, v12, v4
    v_perm_b32 v102, v94, v14, v4
    v_mfma_f32_32x32x16_bf16 v[208:223], v[108:111], v[120:123], v[208:223]
    buffer_load_dwordx4 v[88:91], v3, s[28:31], s82 offen offset:1024
    v_mov_b32_dpp v96, v16 row_ror:8 row_mask:0xf bank_mask:0xf bound_ctrl:0
    v_mov_b32_dpp v98, v18 row_ror:8 row_mask:0xf bank_mask:0xf bound_ctrl:0
    v_perm_b32 v104, v93, v13, v4
    v_perm_b32 v106, v95, v15, v4
    v_permlane16_swap_b32 v100, v102
    v_mfma_f32_32x32x16_bf16 v[224:239], v[112:115], v[116:119], v[224:239]
    ds_read_b128 v[132:135], v145
    v_mov_b32_dpp v97, v17 row_ror:8 row_mask:0xf bank_mask:0xf bound_ctrl:0
    v_mov_b32_dpp v99, v19 row_ror:8 row_mask:0xf bank_mask:0xf bound_ctrl:0
    v_perm_b32 v101, v96, v16, v4
    v_perm_b32 v103, v98, v18, v4
    v_perm_b32 v105, v97, v17, v4
    v_mfma_f32_32x32x16_bf16 v[240:255], v[112:115], v[120:123], v[240:255]
    ds_read_b128 v[136:139], v159
    v_perm_b32 v107, v99, v19, v4
    v_permlane16_swap_b32 v104, v106
    v_permlane16_swap_b32 v101, v103
    v_permlane16_swap_b32 v105, v107
    s_waitcnt lgkmcnt(2)
    v_mfma_f32_32x32x16_bf16 v[192:207], v[100:103], v[124:127], v[192:207]
    buffer_load_dwordx4 v[12:15], v2, s[28:31], s83 offen offset:0
    v_mov_b32_dpp v92, v20 row_ror:8 row_mask:0xf bank_mask:0xf bound_ctrl:0
    v_mov_b32_dpp v94, v22 row_ror:8 row_mask:0xf bank_mask:0xf bound_ctrl:0
    v_mov_b32_dpp v93, v21 row_ror:8 row_mask:0xf bank_mask:0xf bound_ctrl:0
    v_mov_b32_dpp v95, v23 row_ror:8 row_mask:0xf bank_mask:0xf bound_ctrl:0
    v_perm_b32 v108, v92, v20, v4
    v_perm_b32 v110, v94, v22, v4
    v_mfma_f32_32x32x16_bf16 v[208:223], v[100:103], v[128:131], v[208:223]
    buffer_load_dwordx4 v[16:19], v2, s[28:31], s83 offen offset:1024
    v_mov_b32_dpp v96, v24 row_ror:8 row_mask:0xf bank_mask:0xf bound_ctrl:0
    v_mov_b32_dpp v98, v26 row_ror:8 row_mask:0xf bank_mask:0xf bound_ctrl:0
    v_perm_b32 v112, v93, v21, v4
    v_perm_b32 v114, v95, v23, v4
    v_permlane16_swap_b32 v108, v110
    v_mfma_f32_32x32x16_bf16 v[224:239], v[104:107], v[124:127], v[224:239]
    ds_read_b128 v[116:119], v173
    v_mov_b32_dpp v97, v25 row_ror:8 row_mask:0xf bank_mask:0xf bound_ctrl:0
    v_mov_b32_dpp v99, v27 row_ror:8 row_mask:0xf bank_mask:0xf bound_ctrl:0
    v_perm_b32 v109, v96, v24, v4
    v_perm_b32 v111, v98, v26, v4
    v_perm_b32 v113, v97, v25, v4
    v_mfma_f32_32x32x16_bf16 v[240:255], v[104:107], v[128:131], v[240:255]
    ds_read_b128 v[120:123], v186
    v_perm_b32 v115, v99, v27, v4
    v_permlane16_swap_b32 v112, v114
    v_permlane16_swap_b32 v109, v111
    v_permlane16_swap_b32 v113, v115
    s_add_u32 s55, s48, 4
    s_cmp_eq_u32 s55, 5
    s_cselect_b32 exec_lo, 0xffffffff, -1
    s_cselect_b32 exec_hi, 0xffffffff, -1
    s_cmp_gt_u32 s55, 5
    s_cselect_b32 exec_lo, 1, exec_lo
    s_cselect_b32 exec_hi, 0, exec_hi
    s_min_u32 s55, s55, 5
    s_lshl_b32 s56, s55, 10
    s_add_u32 m0, s56, 157264
    s_lshl_b32 s55, s55, 13
    s_add_u32 s55, s55, s58
    s_add_u32 s55, s55, 0
    buffer_load_dwordx4 v5, s[24:27], s55 offen lds
    s_mov_b64 exec, -1
    s_waitcnt lgkmcnt(2)
    v_mfma_f32_32x32x16_bf16 v[192:207], v[108:111], v[132:135], v[192:207]
    buffer_load_dwordx4 v[20:23], v3, s[28:31], s83 offen offset:0
    v_mov_b32_dpp v92, v28 row_ror:8 row_mask:0xf bank_mask:0xf bound_ctrl:0
    v_mov_b32_dpp v94, v30 row_ror:8 row_mask:0xf bank_mask:0xf bound_ctrl:0
    v_mov_b32_dpp v93, v29 row_ror:8 row_mask:0xf bank_mask:0xf bound_ctrl:0
    v_mov_b32_dpp v95, v31 row_ror:8 row_mask:0xf bank_mask:0xf bound_ctrl:0
    v_perm_b32 v100, v92, v28, v4
    v_perm_b32 v102, v94, v30, v4
    v_mfma_f32_32x32x16_bf16 v[208:223], v[108:111], v[136:139], v[208:223]
    buffer_load_dwordx4 v[24:27], v3, s[28:31], s83 offen offset:1024
    v_mov_b32_dpp v96, v32 row_ror:8 row_mask:0xf bank_mask:0xf bound_ctrl:0
    v_mov_b32_dpp v98, v34 row_ror:8 row_mask:0xf bank_mask:0xf bound_ctrl:0
    v_perm_b32 v104, v93, v29, v4
    v_perm_b32 v106, v95, v31, v4
    v_permlane16_swap_b32 v100, v102
    v_mfma_f32_32x32x16_bf16 v[224:239], v[112:115], v[132:135], v[224:239]
    ds_read_b128 v[124:127], v146
    v_mov_b32_dpp v97, v33 row_ror:8 row_mask:0xf bank_mask:0xf bound_ctrl:0
    v_mov_b32_dpp v99, v35 row_ror:8 row_mask:0xf bank_mask:0xf bound_ctrl:0
    v_perm_b32 v101, v96, v32, v4
    v_perm_b32 v103, v98, v34, v4
    v_perm_b32 v105, v97, v33, v4
    v_mfma_f32_32x32x16_bf16 v[240:255], v[112:115], v[136:139], v[240:255]
    ds_read_b128 v[128:131], v160
    v_perm_b32 v107, v99, v35, v4
    v_permlane16_swap_b32 v104, v106
    v_permlane16_swap_b32 v101, v103
    v_permlane16_swap_b32 v105, v107
    s_waitcnt lgkmcnt(2)
    v_mfma_f32_32x32x16_bf16 v[192:207], v[100:103], v[116:119], v[192:207]
    buffer_load_dwordx4 v[28:31], v2, s[28:31], s84 offen offset:0
    v_mov_b32_dpp v92, v36 row_ror:8 row_mask:0xf bank_mask:0xf bound_ctrl:0
    v_mov_b32_dpp v94, v38 row_ror:8 row_mask:0xf bank_mask:0xf bound_ctrl:0
    v_mov_b32_dpp v93, v37 row_ror:8 row_mask:0xf bank_mask:0xf bound_ctrl:0
    v_mov_b32_dpp v95, v39 row_ror:8 row_mask:0xf bank_mask:0xf bound_ctrl:0
    v_perm_b32 v108, v92, v36, v4
    v_perm_b32 v110, v94, v38, v4
    v_mfma_f32_32x32x16_bf16 v[208:223], v[100:103], v[120:123], v[208:223]
    buffer_load_dwordx4 v[32:35], v2, s[28:31], s84 offen offset:1024
    v_mov_b32_dpp v96, v40 row_ror:8 row_mask:0xf bank_mask:0xf bound_ctrl:0
    v_mov_b32_dpp v98, v42 row_ror:8 row_mask:0xf bank_mask:0xf bound_ctrl:0
    v_perm_b32 v112, v93, v37, v4
    v_perm_b32 v114, v95, v39, v4
    v_permlane16_swap_b32 v108, v110
    v_mfma_f32_32x32x16_bf16 v[224:239], v[104:107], v[116:119], v[224:239]
    ds_read_b128 v[132:135], v174
    v_mov_b32_dpp v97, v41 row_ror:8 row_mask:0xf bank_mask:0xf bound_ctrl:0
    v_mov_b32_dpp v99, v43 row_ror:8 row_mask:0xf bank_mask:0xf bound_ctrl:0
    v_perm_b32 v109, v96, v40, v4
    v_perm_b32 v111, v98, v42, v4
    v_perm_b32 v113, v97, v41, v4
    v_mfma_f32_32x32x16_bf16 v[240:255], v[104:107], v[120:123], v[240:255]
    ds_read_b128 v[136:139], v187
    v_perm_b32 v115, v99, v43, v4
    v_permlane16_swap_b32 v112, v114
    v_permlane16_swap_b32 v109, v111
    v_permlane16_swap_b32 v113, v115
    s_waitcnt lgkmcnt(2)
    v_mfma_f32_32x32x16_bf16 v[192:207], v[108:111], v[124:127], v[192:207]
    buffer_load_dwordx4 v[36:39], v3, s[28:31], s84 offen offset:0
    v_mov_b32_dpp v92, v44 row_ror:8 row_mask:0xf bank_mask:0xf bound_ctrl:0
    v_mov_b32_dpp v94, v46 row_ror:8 row_mask:0xf bank_mask:0xf bound_ctrl:0
    v_mov_b32_dpp v93, v45 row_ror:8 row_mask:0xf bank_mask:0xf bound_ctrl:0
    v_mov_b32_dpp v95, v47 row_ror:8 row_mask:0xf bank_mask:0xf bound_ctrl:0
    v_perm_b32 v100, v92, v44, v4
    v_perm_b32 v102, v94, v46, v4
    v_mfma_f32_32x32x16_bf16 v[208:223], v[108:111], v[128:131], v[208:223]
    buffer_load_dwordx4 v[40:43], v3, s[28:31], s84 offen offset:1024
    v_mov_b32_dpp v96, v48 row_ror:8 row_mask:0xf bank_mask:0xf bound_ctrl:0
    v_mov_b32_dpp v98, v50 row_ror:8 row_mask:0xf bank_mask:0xf bound_ctrl:0
    v_perm_b32 v104, v93, v45, v4
    v_perm_b32 v106, v95, v47, v4
    v_permlane16_swap_b32 v100, v102
    v_mfma_f32_32x32x16_bf16 v[224:239], v[112:115], v[124:127], v[224:239]
    ds_read_b128 v[116:119], v147
    v_mov_b32_dpp v97, v49 row_ror:8 row_mask:0xf bank_mask:0xf bound_ctrl:0
    v_mov_b32_dpp v99, v51 row_ror:8 row_mask:0xf bank_mask:0xf bound_ctrl:0
    v_perm_b32 v101, v96, v48, v4
    v_perm_b32 v103, v98, v50, v4
    v_perm_b32 v105, v97, v49, v4
    v_mfma_f32_32x32x16_bf16 v[240:255], v[112:115], v[128:131], v[240:255]
    ds_read_b128 v[120:123], v161
    v_perm_b32 v107, v99, v51, v4
    v_permlane16_swap_b32 v104, v106
    v_permlane16_swap_b32 v101, v103
    v_permlane16_swap_b32 v105, v107
    s_waitcnt vmcnt(18) lgkmcnt(2)
    v_mfma_f32_32x32x16_bf16 v[192:207], v[100:103], v[132:135], v[192:207]
    buffer_load_dwordx4 v[44:47], v2, s[28:31], s85 offen offset:0
    v_mov_b32_dpp v92, v52 row_ror:8 row_mask:0xf bank_mask:0xf bound_ctrl:0
    v_mov_b32_dpp v94, v54 row_ror:8 row_mask:0xf bank_mask:0xf bound_ctrl:0
    v_mov_b32_dpp v93, v53 row_ror:8 row_mask:0xf bank_mask:0xf bound_ctrl:0
    v_mov_b32_dpp v95, v55 row_ror:8 row_mask:0xf bank_mask:0xf bound_ctrl:0
    v_perm_b32 v108, v92, v52, v4
    v_perm_b32 v110, v94, v54, v4
    v_mfma_f32_32x32x16_bf16 v[208:223], v[100:103], v[136:139], v[208:223]
    buffer_load_dwordx4 v[48:51], v2, s[28:31], s85 offen offset:1024
    v_mov_b32_dpp v96, v56 row_ror:8 row_mask:0xf bank_mask:0xf bound_ctrl:0
    v_mov_b32_dpp v98, v58 row_ror:8 row_mask:0xf bank_mask:0xf bound_ctrl:0
    v_perm_b32 v112, v93, v53, v4
    v_perm_b32 v114, v95, v55, v4
    v_permlane16_swap_b32 v108, v110
    v_mfma_f32_32x32x16_bf16 v[224:239], v[104:107], v[132:135], v[224:239]
    ds_read_b128 v[124:127], v175
    v_mov_b32_dpp v97, v57 row_ror:8 row_mask:0xf bank_mask:0xf bound_ctrl:0
    v_mov_b32_dpp v99, v59 row_ror:8 row_mask:0xf bank_mask:0xf bound_ctrl:0
    v_perm_b32 v109, v96, v56, v4
    v_perm_b32 v111, v98, v58, v4
    v_perm_b32 v113, v97, v57, v4
    v_mfma_f32_32x32x16_bf16 v[240:255], v[104:107], v[136:139], v[240:255]
    ds_read_b128 v[128:131], v188
    v_perm_b32 v115, v99, v59, v4
    v_permlane16_swap_b32 v112, v114
    v_permlane16_swap_b32 v109, v111
    v_permlane16_swap_b32 v113, v115
    ds_read_b32 v7, v0 offset:4
    s_waitcnt lgkmcnt(0)
    v_readfirstlane_b32 s100, v7
    s_nop 0
    s_cmp_ge_u32 s100, 4
    s_cbranch_scc1 L_sw1x
L_sw1:
    s_sleep 1
    ds_read_b32 v7, v0 offset:4
    s_waitcnt lgkmcnt(0)
    v_readfirstlane_b32 s100, v7
    s_add_u32 s59, s59, 1
    s_cmp_ge_u32 s59, 0x1000000
    s_cbranch_scc1 L_sw1x
    s_cmp_ge_u32 s100, 4
    s_cbranch_scc0 L_sw1
L_sw1x:
    s_add_u32 s55, s48, 0
    s_lshl_b32 s56, s55, 10
    s_add_u32 m0, s56, 146000
    s_lshl_b32 s55, s55, 13
    s_add_u32 s55, s55, s58
    s_add_u32 s55, s55, 48256
    buffer_load_dwordx4 v5, s[24:27], s55 offen lds
    s_waitcnt vmcnt(19)
    v_mfma_f32_32x32x16_bf16 v[192:207], v[108:111], v[116:119], v[192:207]
    buffer_load_dwordx4 v[52:55], v3, s[28:31], s85 offen offset:0
    v_mov_b32_dpp v92, v60 row_ror:8 row_mask:0xf bank_mask:0xf bound_ctrl:0
    v_mov_b32_dpp v94, v62 row_ror:8 row_mask:0xf bank_mask:0xf bound_ctrl:0
    v_mov_b32_dpp v93, v61 row_ror:8 row_mask:0xf bank_mask:0xf bound_ctrl:0
    v_mov_b32_dpp v95, v63 row_ror:8 row_mask:0xf bank_mask:0xf bound_ctrl:0
    v_perm_b32 v100, v92, v60, v4
    v_perm_b32 v102, v94, v62, v4
    v_mfma_f32_32x32x16_bf16 v[208:223], v[108:111], v[120:123], v[208:223]
    buffer_load_dwordx4 v[56:59], v3, s[28:31], s85 offen offset:1024
    v_mov_b32_dpp v96, v64 row_ror:8 row_mask:0xf bank_mask:0xf bound_ctrl:0
    v_mov_b32_dpp v98, v66 row_ror:8 row_mask:0xf bank_mask:0xf bound_ctrl:0
    v_perm_b32 v104, v93, v61, v4
    v_perm_b32 v106, v95, v63, v4
    v_permlane16_swap_b32 v100, v102
    v_mfma_f32_32x32x16_bf16 v[224:239], v[112:115], v[116:119], v[224:239]
    ds_read_b128 v[132:135], v148
    v_mov_b32_dpp v97, v65 row_ror:8 row_mask:0xf bank_mask:0xf bound_ctrl:0
    v_mov_b32_dpp v99, v67 row_ror:8 row_mask:0xf bank_mask:0xf bound_ctrl:0
    v_perm_b32 v101, v96, v64, v4
    v_perm_b32 v103, v98, v66, v4
    v_perm_b32 v105, v97, v65, v4
    v_mfma_f32_32x32x16_bf16 v[240:255], v[112:115], v[120:123], v[240:255]
    ds_read_b128 v[136:139], v162
    v_perm_b32 v107, v99, v67, v4
    v_permlane16_swap_b32 v104, v106
    v_permlane16_swap_b32 v101, v103
    v_permlane16_swap_b32 v105, v107
    s_add_u32 s55, s48, 4
    s_cmp_eq_u32 s55, 4
    s_cselect_b32 exec_lo, 0xffffffff, -1
    s_cselect_b32 exec_hi, 0x7ff, -1
    s_cmp_gt_u32 s55, 4
    s_cselect_b32 exec_lo, 1, exec_lo
    s_cselect_b32 exec_hi, 0, exec_hi
    s_min_u32 s55, s55, 4
    s_lshl_b32 s56, s55, 10
    s_add_u32 m0, s56, 146000
    s_lshl_b32 s55, s55, 13
    s_add_u32 s55, s55, s58
    s_add_u32 s55, s55, 48256
    buffer_load_dwordx4 v5, s[24:27], s55 offen lds
    s_mov_b64 exec, -1
    s_waitcnt vmcnt(20)
    v_mfma_f32_32x32x16_bf16 v[192:207], v[100:103], v[124:127], v[192:207]
    v_mov_b32_dpp v92, v68 row_ror:8 row_mask:0xf bank_mask:0xf bound_ctrl:0
    v_mov_b32_dpp v94, v70 row_ror:8 row_mask:0xf bank_mask:0xf bound_ctrl:0
    v_mov_b32_dpp v93, v69 row_ror:8 row_mask:0xf bank_mask:0xf bound_ctrl:0
    v_mov_b32_dpp v95, v71 row_ror:8 row_mask:0xf bank_mask:0xf bound_ctrl:0
    v_perm_b32 v108, v92, v68, v4
    v_perm_b32 v110, v94, v70, v4
    v_mfma_f32_32x32x16_bf16 v[208:223], v[100:103], v[128:131], v[208:223]
    v_mov_b32_dpp v96, v72 row_ror:8 row_mask:0xf bank_mask:0xf bound_ctrl:0
    v_mov_b32_dpp v98, v74 row_ror:8 row_mask:0xf bank_mask:0xf bound_ctrl:0
    v_perm_b32 v112, v93, v69, v4
    v_perm_b32 v114, v95, v71, v4
    v_permlane16_swap_b32 v108, v110
    v_mfma_f32_32x32x16_bf16 v[224:239], v[104:107], v[124:127], v[224:239]
    ds_read_b128 v[116:119], v176
    v_mov_b32_dpp v97, v73 row_ror:8 row_mask:0xf bank_mask:0xf bound_ctrl:0
    v_mov_b32_dpp v99, v75 row_ror:8 row_mask:0xf bank_mask:0xf bound_ctrl:0
    v_perm_b32 v109, v96, v72, v4
    v_perm_b32 v111, v98, v74, v4
    v_perm_b32 v113, v97, v73, v4
    v_mfma_f32_32x32x16_bf16 v[240:255], v[104:107], v[128:131], v[240:255]
    ds_read_b128 v[120:123], v189
    v_perm_b32 v115, v99, v75, v4
    v_permlane16_swap_b32 v112, v114
    v_permlane16_swap_b32 v109, v111
    v_permlane16_swap_b32 v113, v115
    s_waitcnt vmcnt(18) lgkmcnt(2)
    v_mfma_f32_32x32x16_bf16 v[192:207], v[108:111], v[132:135], v[192:207]
    v_mov_b32_dpp v92, v76 row_ror:8 row_mask:0xf bank_mask:0xf bound_ctrl:0
    v_mov_b32_dpp v94, v78 row_ror:8 row_mask:0xf bank_mask:0xf bound_ctrl:0
    v_mov_b32_dpp v93, v77 row_ror:8 row_mask:0xf bank_mask:0xf bound_ctrl:0
    v_mov_b32_dpp v95, v79 row_ror:8 row_mask:0xf bank_mask:0xf bound_ctrl:0
    v_perm_b32 v100, v92, v76, v4
    v_perm_b32 v102, v94, v78, v4
    v_mfma_f32_32x32x16_bf16 v[208:223], v[108:111], v[136:139], v[208:223]
    v_mov_b32_dpp v96, v80 row_ror:8 row_mask:0xf bank_mask:0xf bound_ctrl:0
    v_mov_b32_dpp v98, v82 row_ror:8 row_mask:0xf bank_mask:0xf bound_ctrl:0
    v_perm_b32 v104, v93, v77, v4
    v_perm_b32 v106, v95, v79, v4
    v_permlane16_swap_b32 v100, v102
    v_mfma_f32_32x32x16_bf16 v[224:239], v[112:115], v[132:135], v[224:239]
    ds_read_b128 v[124:127], v149
    v_mov_b32_dpp v97, v81 row_ror:8 row_mask:0xf bank_mask:0xf bound_ctrl:0
    v_mov_b32_dpp v99, v83 row_ror:8 row_mask:0xf bank_mask:0xf bound_ctrl:0
    v_perm_b32 v101, v96, v80, v4
    v_perm_b32 v103, v98, v82, v4
    v_perm_b32 v105, v97, v81, v4
    v_mfma_f32_32x32x16_bf16 v[240:255], v[112:115], v[136:139], v[240:255]
    ds_read_b128 v[128:131], v163
    v_perm_b32 v107, v99, v83, v4
    v_permlane16_swap_b32 v104, v106
    v_permlane16_swap_b32 v101, v103
    v_permlane16_swap_b32 v105, v107
    s_waitcnt vmcnt(15) lgkmcnt(2)
    v_mfma_f32_32x32x16_bf16 v[192:207], v[100:103], v[116:119], v[192:207]
    v_mov_b32_dpp v92, v84 row_ror:8 row_mask:0xf bank_mask:0xf bound_ctrl:0
    v_mov_b32_dpp v94, v86 row_ror:8 row_mask:0xf bank_mask:0xf bound_ctrl:0
    v_mov_b32_dpp v93, v85 row_ror:8 row_mask:0xf bank_mask:0xf bound_ctrl:0
    v_mov_b32_dpp v95, v87 row_ror:8 row_mask:0xf bank_mask:0xf bound_ctrl:0
    v_perm_b32 v108, v92, v84, v4
    v_perm_b32 v110, v94, v86, v4
    v_mfma_f32_32x32x16_bf16 v[208:223], v[100:103], v[120:123], v[208:223]
    v_mov_b32_dpp v96, v88 row_ror:8 row_mask:0xf bank_mask:0xf bound_ctrl:0
    v_mov_b32_dpp v98, v90 row_ror:8 row_mask:0xf bank_mask:0xf bound_ctrl:0
    v_perm_b32 v112, v93, v85, v4
    v_perm_b32 v114, v95, v87, v4
    v_permlane16_swap_b32 v108, v110
    v_mfma_f32_32x32x16_bf16 v[224:239], v[104:107], v[116:119], v[224:239]
    ds_read_b128 v[132:135], v177
    v_mov_b32_dpp v97, v89 row_ror:8 row_mask:0xf bank_mask:0xf bound_ctrl:0
    v_mov_b32_dpp v99, v91 row_ror:8 row_mask:0xf bank_mask:0xf bound_ctrl:0
    v_perm_b32 v109, v96, v88, v4
    v_perm_b32 v111, v98, v90, v4
    v_perm_b32 v113, v97, v89, v4
    v_mfma_f32_32x32x16_bf16 v[240:255], v[104:107], v[120:123], v[240:255]
    ds_read_b128 v[136:139], v190
    v_perm_b32 v115, v99, v91, v4
    v_permlane16_swap_b32 v112, v114
    v_permlane16_swap_b32 v109, v111
    v_permlane16_swap_b32 v113, v115
    s_waitcnt vmcnt(13) lgkmcnt(2)
    v_mfma_f32_32x32x16_bf16 v[192:207], v[108:111], v[124:127], v[192:207]
    v_mov_b32_dpp v92, v12 row_ror:8 row_mask:0xf bank_mask:0xf bound_ctrl:0
    v_mov_b32_dpp v94, v14 row_ror:8 row_mask:0xf bank_mask:0xf bound_ctrl:0
    v_mov_b32_dpp v93, v13 row_ror:8 row_mask:0xf bank_mask:0xf bound_ctrl:0
    v_mov_b32_dpp v95, v15 row_ror:8 row_mask:0xf bank_mask:0xf bound_ctrl:0
    v_perm_b32 v100, v92, v12, v4
    v_perm_b32 v102, v94, v14, v4
    v_mfma_f32_32x32x16_bf16 v[208:223], v[108:111], v[128:131], v[208:223]
    v_mov_b32_dpp v96, v16 row_ror:8 row_mask:0xf bank_mask:0xf bound_ctrl:0
    v_mov_b32_dpp v98, v18 row_ror:8 row_mask:0xf bank_mask:0xf bound_ctrl:0
    v_perm_b32 v104, v93, v13, v4
    v_perm_b32 v106, v95, v15, v4
    v_permlane16_swap_b32 v100, v102
    v_mfma_f32_32x32x16_bf16 v[224:239], v[112:115], v[124:127], v[224:239]
    ds_read_b128 v[116:119], v150
    v_mov_b32_dpp v97, v17 row_ror:8 row_mask:0xf bank_mask:0xf bound_ctrl:0
    v_mov_b32_dpp v99, v19 row_ror:8 row_mask:0xf bank_mask:0xf bound_ctrl:0
    v_perm_b32 v101, v96, v16, v4
    v_perm_b32 v103, v98, v18, v4
    v_perm_b32 v105, v97, v17, v4
    v_mfma_f32_32x32x16_bf16 v[240:255], v[112:115], v[128:131], v[240:255]
    ds_read_b128 v[120:123], v164
    v_perm_b32 v107, v99, v19, v4
    v_permlane16_swap_b32 v104, v106
    v_permlane16_swap_b32 v101, v103
    v_permlane16_swap_b32 v105, v107
    s_waitcnt vmcnt(0)
    s_mov_b64 exec, 1
    ds_add_u32 v0, v10 offset:8
    s_mov_b64 exec, -1
    s_waitcnt lgkmcnt(3)
    v_mfma_f32_32x32x16_bf16 v[192:207], v[100:103], v[132:135], v[192:207]
    v_mov_b32_dpp v92, v20 row_ror:8 row_mask:0xf bank_mask:0xf bound_ctrl:0
    v_mov_b32_dpp v94, v22 row_ror:8 row_mask:0xf bank_mask:0xf bound_ctrl:0
    v_mov_b32_dpp v93, v21 row_ror:8 row_mask:0xf bank_mask:0xf bound_ctrl:0
    v_mov_b32_dpp v95, v23 row_ror:8 row_mask:0xf bank_mask:0xf bound_ctrl:0
    v_perm_b32 v108, v92, v20, v4
    v_perm_b32 v110, v94, v22, v4
    v_mfma_f32_32x32x16_bf16 v[208:223], v[100:103], v[136:139], v[208:223]
    v_mov_b32_dpp v96, v24 row_ror:8 row_mask:0xf bank_mask:0xf bound_ctrl:0
    v_mov_b32_dpp v98, v26 row_ror:8 row_mask:0xf bank_mask:0xf bound_ctrl:0
    v_perm_b32 v112, v93, v21, v4
    v_perm_b32 v114, v95, v23, v4
    v_permlane16_swap_b32 v108, v110
    v_mfma_f32_32x32x16_bf16 v[224:239], v[104:107], v[132:135], v[224:239]
    ds_read_b128 v[124:127], v178
    v_mov_b32_dpp v97, v25 row_ror:8 row_mask:0xf bank_mask:0xf bound_ctrl:0
    v_mov_b32_dpp v99, v27 row_ror:8 row_mask:0xf bank_mask:0xf bound_ctrl:0
    v_perm_b32 v109, v96, v24, v4
    v_perm_b32 v111, v98, v26, v4
    v_perm_b32 v113, v97, v25, v4
    v_mfma_f32_32x32x16_bf16 v[240:255], v[104:107], v[136:139], v[240:255]
    ds_read_b128 v[128:131], v191
    v_perm_b32 v115, v99, v27, v4
    v_permlane16_swap_b32 v112, v114
    v_permlane16_swap_b32 v109, v111
    v_permlane16_swap_b32 v113, v115
    s_setprio 2
    v_lshrrev_b32 v6, 3, v1
    v_bfe_u32 v7, v1, 1, 2
    v_lshlrev_b32 v6, 11, v6
    v_lshl_or_b32 v6, v7, 9, v6
    v_lshl_or_b32 v6, v7, 5, v6
    v_and_b32 v7, 1, v1
    v_lshl_or_b32 v6, v7, 4, v6
    v_xor_b32 v140, s57, v6
    v_xor_b32 v141, 16, v140
    s_lshr_b32 s56, s51, 2
    s_xor_b32 s55, s48, 1
    s_add_u32 s55, s55, s56
    s_and_b32 s55, s55, 3
    s_lshl_b32 s55, s55, 5
    v_xor_b32 v142, s55, v6
    v_xor_b32 v143, 16, v142
    s_lshr_b32 s56, s51, 2
    s_xor_b32 s55, s48, 2
    s_add_u32 s55, s55, s56
    s_and_b32 s55, s55, 3
    s_lshl_b32 s55, s55, 5
    v_xor_b32 v144, s55, v6
    v_xor_b32 v145, 16, v144
    s_lshr_b32 s56, s51, 2
    s_xor_b32 s55, s48, 3
    s_add_u32 s55, s55, s56
    s_and_b32 s55, s55, 3
    s_lshl_b32 s55, s55, 5
    v_xor_b32 v146, s55, v6
    v_xor_b32 v147, 16, v146
    s_waitcnt lgkmcnt(3)
    v_mfma_f32_32x32x16_bf16 v[192:207], v[108:111], v[116:119], v[192:207]
    v_mov_b32_dpp v92, v28 row_ror:8 row_mask:0xf bank_mask:0xf bound_ctrl:0
    v_mov_b32_dpp v94, v30 row_ror:8 row_mask:0xf bank_mask:0xf bound_ctrl:0
    v_mov_b32_dpp v93, v29 row_ror:8 row_mask:0xf bank_mask:0xf bound_ctrl:0
    v_mov_b32_dpp v95, v31 row_ror:8 row_mask:0xf bank_mask:0xf bound_ctrl:0
    v_perm_b32 v100, v92, v28, v4
    v_perm_b32 v102, v94, v30, v4
    v_mfma_f32_32x32x16_bf16 v[208:223], v[108:111], v[120:123], v[208:223]
    v_mov_b32_dpp v96, v32 row_ror:8 row_mask:0xf bank_mask:0xf bound_ctrl:0
    v_mov_b32_dpp v98, v34 row_ror:8 row_mask:0xf bank_mask:0xf bound_ctrl:0
    v_perm_b32 v104, v93, v29, v4
    v_perm_b32 v106, v95, v31, v4
    v_permlane16_swap_b32 v100, v102
    v_mfma_f32_32x32x16_bf16 v[224:239], v[112:115], v[116:119], v[224:239]
    ds_read_b128 v[132:135], v151
    v_mov_b32_dpp v97, v33 row_ror:8 row_mask:0xf bank_mask:0xf bound_ctrl:0
    v_mov_b32_dpp v99, v35 row_ror:8 row_mask:0xf bank_mask:0xf bound_ctrl:0
    v_perm_b32 v101, v96, v32, v4
    v_perm_b32 v103, v98, v34, v4
    v_perm_b32 v105, v97, v33, v4
    v_mfma_f32_32x32x16_bf16 v[240:255], v[112:115], v[120:123], v[240:255]
    ds_read_b128 v[136:139], v165
    v_perm_b32 v107, v99, v35, v4
    v_permlane16_swap_b32 v104, v106
    v_permlane16_swap_b32 v101, v103
    v_permlane16_swap_b32 v105, v107
    v_mov_b32 v9, 0xbdd2d3e8
    s_and_b32 s60, s50, 1
    s_lshl_b32 s60, s60, 1
    s_lshr_b32 s56, s48, 1
    s_add_u32 s60, s60, s56
    s_lshl_b32 s60, s60, 11
    s_lshl_b32 s56, s53, 13
    s_add_u32 s60, s60, s56
    s_lshl_b32 s56, s49, 7
    s_add_u32 s60, s60, s56
    s_and_b32 s56, s48, 1
    s_lshl_b32 s56, s56, 6
    s_add_u32 s60, s60, s56
    s_add_u32 s60, s60, 512
    ds_read_b32 v7, v0 offset:12
    s_waitcnt lgkmcnt(0)
    v_readfirstlane_b32 s100, v7
    s_nop 0
    s_cmp_ge_u32 s100, 4
    s_cbranch_scc1 L_sw2x
L_sw2:
    s_sleep 1
    ds_read_b32 v7, v0 offset:12
    s_waitcnt lgkmcnt(0)
    v_readfirstlane_b32 s100, v7
    s_add_u32 s59, s59, 1
    s_cmp_ge_u32 s59, 0x1000000
    s_cbranch_scc1 L_sw2x
    s_cmp_ge_u32 s100, 4
    s_cbranch_scc0 L_sw2
L_sw2x:
    v_mfma_f32_32x32x16_bf16 v[192:207], v[100:103], v[124:127], v[192:207]
    v_mov_b32_dpp v92, v36 row_ror:8 row_mask:0xf bank_mask:0xf bound_ctrl:0
    v_mov_b32_dpp v94, v38 row_ror:8 row_mask:0xf bank_mask:0xf bound_ctrl:0
    v_mov_b32_dpp v93, v37 row_ror:8 row_mask:0xf bank_mask:0xf bound_ctrl:0
    v_mov_b32_dpp v95, v39 row_ror:8 row_mask:0xf bank_mask:0xf bound_ctrl:0
    v_perm_b32 v108, v92, v36, v4
    v_perm_b32 v110, v94, v38, v4
    v_mfma_f32_32x32x16_bf16 v[208:223], v[100:103], v[128:131], v[208:223]
    v_mov_b32_dpp v96, v40 row_ror:8 row_mask:0xf bank_mask:0xf bound_ctrl:0
    v_mov_b32_dpp v98, v42 row_ror:8 row_mask:0xf bank_mask:0xf bound_ctrl:0
    v_perm_b32 v112, v93, v37, v4
    v_perm_b32 v114, v95, v39, v4
    v_permlane16_swap_b32 v108, v110
    v_mfma_f32_32x32x16_bf16 v[224:239], v[104:107], v[124:127], v[224:239]
    ds_read_b128 v[116:119], v179
    v_mov_b32_dpp v97, v41 row_ror:8 row_mask:0xf bank_mask:0xf bound_ctrl:0
    v_mov_b32_dpp v99, v43 row_ror:8 row_mask:0xf bank_mask:0xf bound_ctrl:0
    v_perm_b32 v109, v96, v40, v4
    v_perm_b32 v111, v98, v42, v4
    v_perm_b32 v113, v97, v41, v4
    v_mfma_f32_32x32x16_bf16 v[240:255], v[104:107], v[128:131], v[240:255]
    ds_read_b128 v[120:123], v153
    v_perm_b32 v115, v99, v43, v4
    v_permlane16_swap_b32 v112, v114
    v_permlane16_swap_b32 v109, v111
    v_permlane16_swap_b32 v113, v115
    v_lshrrev_b32 v8, 5, v1
    v_lshlrev_b32 v8, 6, v8
    s_lshl_b32 s55, s49, 7
    s_and_b32 s56, s48, 1
    s_lshl_b32 s56, s56, 2
    s_add_u32 s55, s55, s56
    buffer_load_dwordx3 v[12:14], v8, s[32:35], s55 offen offset:0
    buffer_load_dwordx3 v[16:18], v8, s[32:35], s55 offen offset:16
    buffer_load_dwordx3 v[20:22], v8, s[32:35], s55 offen offset:32
    buffer_load_dwordx3 v[24:26], v8, s[32:35], s55 offen offset:48
    v_mfma_f32_32x32x16_bf16 v[192:207], v[108:111], v[132:135], v[192:207]
    v_mov_b32_dpp v92, v44 row_ror:8 row_mask:0xf bank_mask:0xf bound_ctrl:0
    v_mov_b32_dpp v94, v46 row_ror:8 row_mask:0xf bank_mask:0xf bound_ctrl:0
    v_mov_b32_dpp v93, v45 row_ror:8 row_mask:0xf bank_mask:0xf bound_ctrl:0
    v_mov_b32_dpp v95, v47 row_ror:8 row_mask:0xf bank_mask:0xf bound_ctrl:0
    v_perm_b32 v100, v92, v44, v4
    v_perm_b32 v102, v94, v46, v4
    v_mfma_f32_32x32x16_bf16 v[208:223], v[108:111], v[136:139], v[208:223]
    v_mov_b32_dpp v96, v48 row_ror:8 row_mask:0xf bank_mask:0xf bound_ctrl:0
    v_mov_b32_dpp v98, v50 row_ror:8 row_mask:0xf bank_mask:0xf bound_ctrl:0
    v_perm_b32 v104, v93, v45, v4
    v_perm_b32 v106, v95, v47, v4
    v_permlane16_swap_b32 v100, v102
    v_mfma_f32_32x32x16_bf16 v[224:239], v[112:115], v[132:135], v[224:239]
    ds_read_b128 v[124:127], v152
    v_mov_b32_dpp v97, v49 row_ror:8 row_mask:0xf bank_mask:0xf bound_ctrl:0
    v_mov_b32_dpp v99, v51 row_ror:8 row_mask:0xf bank_mask:0xf bound_ctrl:0
    v_perm_b32 v101, v96, v48, v4
    v_perm_b32 v103, v98, v50, v4
    v_perm_b32 v105, v97, v49, v4
    v_mfma_f32_32x32x16_bf16 v[240:255], v[112:115], v[136:139], v[240:255]
    ds_read_b128 v[128:131], v166
    v_perm_b32 v107, v99, v51, v4
    v_permlane16_swap_b32 v104, v106
    v_permlane16_swap_b32 v101, v103
    v_permlane16_swap_b32 v105, v107
    s_waitcnt lgkmcnt(2)
    v_mfma_f32_32x32x16_bf16 v[192:207], v[100:103], v[116:119], v[192:207]
    v_mov_b32_dpp v92, v52 row_ror:8 row_mask:0xf bank_mask:0xf bound_ctrl:0
    v_mov_b32_dpp v94, v54 row_ror:8 row_mask:0xf bank_mask:0xf bound_ctrl:0
    v_mov_b32_dpp v93, v53 row_ror:8 row_mask:0xf bank_mask:0xf bound_ctrl:0
    v_mov_b32_dpp v95, v55 row_ror:8 row_mask:0xf bank_mask:0xf bound_ctrl:0
    v_perm_b32 v108, v92, v52, v4
    v_perm_b32 v110, v94, v54, v4
    v_mfma_f32_32x32x16_bf16 v[208:223], v[100:103], v[120:123], v[208:223]
    v_mov_b32_dpp v96, v56 row_ror:8 row_mask:0xf bank_mask:0xf bound_ctrl:0
    v_mov_b32_dpp v98, v58 row_ror:8 row_mask:0xf bank_mask:0xf bound_ctrl:0
    v_perm_b32 v112, v93, v53, v4
    v_perm_b32 v114, v95, v55, v4
    v_permlane16_swap_b32 v108, v110
    v_mfma_f32_32x32x16_bf16 v[224:239], v[104:107], v[116:119], v[224:239]
    v_mov_b32_dpp v97, v57 row_ror:8 row_mask:0xf bank_mask:0xf bound_ctrl:0
    v_mov_b32_dpp v99, v59 row_ror:8 row_mask:0xf bank_mask:0xf bound_ctrl:0
    v_perm_b32 v109, v96, v56, v4
    v_perm_b32 v111, v98, v58, v4
    v_perm_b32 v113, v97, v57, v4
    v_mfma_f32_32x32x16_bf16 v[240:255], v[104:107], v[120:123], v[240:255]
    v_perm_b32 v115, v99, v59, v4
    v_permlane16_swap_b32 v112, v114
    v_permlane16_swap_b32 v109, v111
    v_permlane16_swap_b32 v113, v115
    v_bfe_u32 v7, v1, 4, 1
    v_and_b32 v8, 15, v1
    v_lshlrev_b32 v8, 2, v8
    v_lshl_add_u32 v8, v7, 10, v8
    ds_read_b32 v7, v0 offset:20
    s_waitcnt lgkmcnt(0)
    v_readfirstlane_b32 s100, v7
    s_nop 0
    s_cmp_ge_u32 s100, 1
    s_cbranch_scc1 L_sw3x
L_sw3:
    s_sleep 2
    ds_read_b32 v7, v0 offset:20
    s_waitcnt lgkmcnt(0)
    v_readfirstlane_b32 s100, v7
    s_add_u32 s59, s59, 1
    s_cmp_ge_u32 s59, 0x1000000
    s_cbranch_scc1 L_sw3x
    s_cmp_ge_u32 s100, 1
    s_cbranch_scc0 L_sw3
L_sw3x:
    s_mov_b32 s61, s100
    v_mfma_f32_32x32x16_bf16 v[192:207], v[108:111], v[124:127], v[192:207]
    v_mfma_f32_32x32x16_bf16 v[208:223], v[108:111], v[128:131], v[208:223]
    v_mfma_f32_32x32x16_bf16 v[224:239], v[112:115], v[124:127], v[224:239]
    v_mfma_f32_32x32x16_bf16 v[240:255], v[112:115], v[128:131], v[240:255]
    s_bitcmp1_b32 s48, 0
    s_cbranch_scc1 L_dep1
    s_nop 7
    v_cvt_pk_bf16_f32 v100, v208, v209
    v_cvt_pk_bf16_f32 v101, v210, v211
    v_cvt_pk_bf16_f32 v102, v212, v213
    v_cvt_pk_bf16_f32 v103, v214, v215
    v_cvt_pk_bf16_f32 v104, v216, v217
    v_cvt_pk_bf16_f32 v105, v218, v219
    v_cvt_pk_bf16_f32 v106, v220, v221
    v_cvt_pk_bf16_f32 v107, v222, v223
    ds_write_b128 v140, v[100:103] offset:16384
    ds_write_b128 v140, v[104:107] offset:16512
    v_cvt_pk_bf16_f32 v92, v224, v225
    v_cvt_pk_bf16_f32 v93, v226, v227
    v_cvt_pk_bf16_f32 v94, v228, v229
    v_cvt_pk_bf16_f32 v95, v230, v231
    v_cvt_pk_bf16_f32 v96, v232, v233
    v_cvt_pk_bf16_f32 v97, v234, v235
    v_cvt_pk_bf16_f32 v98, v236, v237
    v_cvt_pk_bf16_f32 v99, v238, v239
    ds_write_b128 v140, v[92:95] offset:0
    ds_write_b128 v140, v[96:99] offset:128
    v_cvt_pk_bf16_f32 v108, v240, v241
    v_cvt_pk_bf16_f32 v109, v242, v243
    v_cvt_pk_bf16_f32 v110, v244, v245
    v_cvt_pk_bf16_f32 v111, v246, v247
    v_cvt_pk_bf16_f32 v112, v248, v249
    v_cvt_pk_bf16_f32 v113, v250, v251
    v_cvt_pk_bf16_f32 v114, v252, v253
    v_cvt_pk_bf16_f32 v115, v254, v255
    ds_write_b128 v140, v[108:111] offset:32768
    ds_write_b128 v140, v[112:115] offset:32896
    s_mov_b64 exec, 1
    ds_add_u32 v0, v10 offset:16
    s_mov_b64 exec, -1
    s_waitcnt vmcnt(3)
    v_lshlrev_b32 v148, 16, v12
    s_waitcnt vmcnt(2)
    v_lshlrev_b32 v149, 16, v16
    s_waitcnt vmcnt(1)
    v_lshlrev_b32 v150, 16, v20
    s_waitcnt vmcnt(0)
    v_lshlrev_b32 v151, 16, v24
    v_and_b32 v152, 0xffff0000, v12
    v_and_b32 v153, 0xffff0000, v16
    v_and_b32 v154, 0xffff0000, v20
    v_and_b32 v155, 0xffff0000, v24
    v_lshlrev_b32 v156, 16, v14
    v_lshlrev_b32 v157, 16, v18
    v_lshlrev_b32 v158, 16, v22
    v_lshlrev_b32 v159, 16, v26
    v_and_b32 v160, 0xffff0000, v14
    v_and_b32 v161, 0xffff0000, v18
    v_and_b32 v162, 0xffff0000, v22
    v_and_b32 v163, 0xffff0000, v26
    v_mov_b32 v2, 0x3f80
    v_mov_b32 v3, 0x3f800000
    ds_read_b32 v7, v0 offset:16
    s_waitcnt lgkmcnt(0)
    v_readfirstlane_b32 s100, v7
    s_nop 0
    s_cmp_ge_u32 s100, 4
    s_cbranch_scc1 L_sw4x
L_sw4:
    s_sleep 1
    ds_read_b32 v7, v0 offset:16
    s_waitcnt lgkmcnt(0)
    v_readfirstlane_b32 s100, v7
    s_add_u32 s59, s59, 1
    s_cmp_ge_u32 s59, 0x1000000
    s_cbranch_scc1 L_sw4x
    s_cmp_ge_u32 s100, 4
    s_cbranch_scc0 L_sw4
L_sw4x:
    ds_read_b128 v[116:119], v142 offset:0
    ds_read_b128 v[124:127], v144 offset:16384
    ds_read_b128 v[132:135], v146 offset:32768
    ds_read_b128 v[120:123], v142 offset:128
    ds_read_b128 v[128:131], v144 offset:16512
    ds_read_b128 v[136:139], v146 offset:32896
    s_waitcnt lgkmcnt(5)
    v_dot2_f32_bf16 v192, v116, v2, v192
    v_dot2_f32_bf16 v193, v116, v3, v193
    v_dot2_f32_bf16 v194, v117, v2, v194
    v_dot2_f32_bf16 v195, v117, v3, v195
    v_dot2_f32_bf16 v196, v118, v2, v196
    v_dot2_f32_bf16 v197, v118, v3, v197
    v_dot2_f32_bf16 v198, v119, v2, v198
    v_dot2_f32_bf16 v199, v119, v3, v199
    s_waitcnt lgkmcnt(4)
    v_dot2_f32_bf16 v192, v124, v2, v192
    v_dot2_f32_bf16 v193, v124, v3, v193
    v_dot2_f32_bf16 v194, v125, v2, v194
    v_dot2_f32_bf16 v195, v125, v3, v195
    v_dot2_f32_bf16 v196, v126, v2, v196
    v_dot2_f32_bf16 v197, v126, v3, v197
    v_dot2_f32_bf16 v198, v127, v2, v198
    v_dot2_f32_bf16 v199, v127, v3, v199
    s_waitcnt lgkmcnt(3)
    v_dot2_f32_bf16 v192, v132, v2, v192
    v_dot2_f32_bf16 v193, v132, v3, v193
    v_dot2_f32_bf16 v194, v133, v2, v194
    v_dot2_f32_bf16 v195, v133, v3, v195
    v_dot2_f32_bf16 v196, v134, v2, v196
    v_dot2_f32_bf16 v197, v134, v3, v197
    v_dot2_f32_bf16 v198, v135, v2, v198
    v_dot2_f32_bf16 v199, v135, v3, v199
    s_waitcnt lgkmcnt(2)
    v_dot2_f32_bf16 v200, v120, v2, v200
    v_dot2_f32_bf16 v201, v120, v3, v201
    v_dot2_f32_bf16 v202, v121, v2, v202
    v_dot2_f32_bf16 v203, v121, v3, v203
    v_dot2_f32_bf16 v204, v122, v2, v204
    v_dot2_f32_bf16 v205, v122, v3, v205
    v_dot2_f32_bf16 v206, v123, v2, v206
    v_dot2_f32_bf16 v207, v123, v3, v207
    s_waitcnt lgkmcnt(1)
    v_dot2_f32_bf16 v200, v128, v2, v200
    v_dot2_f32_bf16 v201, v128, v3, v201
    v_dot2_f32_bf16 v202, v129, v2, v202
    v_dot2_f32_bf16 v203, v129, v3, v203
    v_dot2_f32_bf16 v204, v130, v2, v204
    v_dot2_f32_bf16 v205, v130, v3, v205
    v_dot2_f32_bf16 v206, v131, v2, v206
    v_dot2_f32_bf16 v207, v131, v3, v207
    s_waitcnt lgkmcnt(0)
    v_dot2_f32_bf16 v200, v136, v2, v200
    v_dot2_f32_bf16 v201, v136, v3, v201
    v_dot2_f32_bf16 v202, v137, v2, v202
    v_dot2_f32_bf16 v203, v137, v3, v203
    v_dot2_f32_bf16 v204, v138, v2, v204
    v_dot2_f32_bf16 v205, v138, v3, v205
    v_dot2_f32_bf16 v206, v139, v2, v206
    v_dot2_f32_bf16 v207, v139, v3, v207
    v_mul_f32 v164, v192, v192
    v_mul_f32 v165, v193, v193
    v_mul_f32 v166, v194, v194
    v_mul_f32 v167, v195, v195
    v_mul_f32 v168, v196, v196
    v_mul_f32 v169, v197, v197
    v_mul_f32 v170, v198, v198
    v_mul_f32 v171, v199, v199
    v_mul_f32 v172, v200, v200
    v_mul_f32 v173, v201, v201
    v_mul_f32 v174, v202, v202
    v_mul_f32 v175, v203, v203
    v_mul_f32 v176, v204, v204
    v_mul_f32 v177, v205, v205
    v_mul_f32 v178, v206, v206
    v_mul_f32 v179, v207, v207
    v_fmaak_f32 v164, v9, v164, 0xc0135761
    v_fmaak_f32 v165, v9, v165, 0xc0135761
    v_fmaak_f32 v166, v9, v166, 0xc0135761
    v_fmaak_f32 v167, v9, v167, 0xc0135761
    v_fmaak_f32 v168, v9, v168, 0xc0135761
    v_fmaak_f32 v169, v9, v169, 0xc0135761
    v_fmaak_f32 v170, v9, v170, 0xc0135761
    v_fmaak_f32 v171, v9, v171, 0xc0135761
    v_fmaak_f32 v172, v9, v172, 0xc0135761
    v_fmaak_f32 v173, v9, v173, 0xc0135761
    v_fmaak_f32 v174, v9, v174, 0xc0135761
    v_fmaak_f32 v175, v9, v175, 0xc0135761
    v_fmaak_f32 v176, v9, v176, 0xc0135761
    v_fmaak_f32 v177, v9, v177, 0xc0135761
    v_fmaak_f32 v178, v9, v178, 0xc0135761
    v_fmaak_f32 v179, v9, v179, 0xc0135761
    v_mul_f32 v164, v164, v192
    v_mul_f32 v165, v165, v193
    v_mul_f32 v166, v166, v194
    v_mul_f32 v167, v167, v195
    v_mul_f32 v168, v168, v196
    v_mul_f32 v169, v169, v197
    v_mul_f32 v170, v170, v198
    v_mul_f32 v171, v171, v199
    v_mul_f32 v172, v172, v200
    v_mul_f32 v173, v173, v201
    v_mul_f32 v174, v174, v202
    v_mul_f32 v175, v175, v203
    v_mul_f32 v176, v176, v204
    v_mul_f32 v177, v177, v205
    v_mul_f32 v178, v178, v206
    v_mul_f32 v179, v179, v207
    v_exp_f32 v164, v164
    v_exp_f32 v165, v165
    v_exp_f32 v166, v166
    v_exp_f32 v167, v167
    v_exp_f32 v168, v168
    v_exp_f32 v169, v169
    v_exp_f32 v170, v170
    v_exp_f32 v171, v171
    v_exp_f32 v172, v172
    v_exp_f32 v173, v173
    v_exp_f32 v174, v174
    v_exp_f32 v175, v175
    v_exp_f32 v176, v176
    v_exp_f32 v177, v177
    v_exp_f32 v178, v178
    v_exp_f32 v179, v179
    v_add_f32 v164, 1.0, v164
    v_add_f32 v165, 1.0, v165
    v_add_f32 v166, 1.0, v166
    v_add_f32 v167, 1.0, v167
    v_add_f32 v168, 1.0, v168
    v_add_f32 v169, 1.0, v169
    v_add_f32 v170, 1.0, v170
    v_add_f32 v171, 1.0, v171
    v_add_f32 v172, 1.0, v172
    v_add_f32 v173, 1.0, v173
    v_add_f32 v174, 1.0, v174
    v_add_f32 v175, 1.0, v175
    v_add_f32 v176, 1.0, v176
    v_add_f32 v177, 1.0, v177
    v_add_f32 v178, 1.0, v178
    v_add_f32 v179, 1.0, v179
    v_rcp_f32 v164, v164
    v_rcp_f32 v165, v165
    v_rcp_f32 v166, v166
    v_rcp_f32 v167, v167
    v_rcp_f32 v168, v168
    v_rcp_f32 v169, v169
    v_rcp_f32 v170, v170
    v_rcp_f32 v171, v171
    v_rcp_f32 v172, v172
    v_rcp_f32 v173, v173
    v_rcp_f32 v174, v174
    v_rcp_f32 v175, v175
    v_rcp_f32 v176, v176
    v_rcp_f32 v177, v177
    v_rcp_f32 v178, v178
    v_rcp_f32 v179, v179
    v_mul_f32 v192, v192, v164
    v_mul_f32 v193, v193, v165
    v_mul_f32 v194, v194, v166
    v_mul_f32 v195, v195, v167
    v_mul_f32 v196, v196, v168
    v_mul_f32 v197, v197, v169
    v_mul_f32 v198, v198, v170
    v_mul_f32 v199, v199, v171
    v_mul_f32 v200, v200, v172
    v_mul_f32 v201, v201, v173
    v_mul_f32 v202, v202, v174
    v_mul_f32 v203, v203, v175
    v_mul_f32 v204, v204, v176
    v_mul_f32 v205, v205, v177
    v_mul_f32 v206, v206, v178
    v_mul_f32 v207, v207, v179
    v_mul_f32 v10, v192, v148
    v_mul_f32 v11, v193, v149
    v_fmac_f32 v10, v194, v150
    v_fmac_f32 v11, v195, v151
    v_fmac_f32 v10, v196, v152
    v_fmac_f32 v11, v197, v153
    v_fmac_f32 v10, v198, v154
    v_fmac_f32 v11, v199, v155
    v_fmac_f32 v10, v200, v156
    v_fmac_f32 v11, v201, v157
    v_fmac_f32 v10, v202, v158
    v_fmac_f32 v11, v203, v159
    v_fmac_f32 v10, v204, v160
    v_fmac_f32 v11, v205, v161
    v_fmac_f32 v10, v206, v162
    v_fmac_f32 v11, v207, v163
    v_add_f32 v10, v10, v11
    s_branch L_dpre
L_dep1:
    s_nop 6
    v_cvt_pk_bf16_f32 v92, v192, v193
    v_cvt_pk_bf16_f32 v93, v194, v195
    v_cvt_pk_bf16_f32 v94, v196, v197
    v_cvt_pk_bf16_f32 v95, v198, v199
    v_cvt_pk_bf16_f32 v96, v200, v201
    v_cvt_pk_bf16_f32 v97, v202, v203
    v_cvt_pk_bf16_f32 v98, v204, v205
    v_cvt_pk_bf16_f32 v99, v206, v207
    ds_write_b128 v140, v[92:95] offset:0
    ds_write_b128 v140, v[96:99] offset:128
    v_cvt_pk_bf16_f32 v108, v208, v209
    v_cvt_pk_bf16_f32 v109, v210, v211
    v_cvt_pk_bf16_f32 v110, v212, v213
    v_cvt_pk_bf16_f32 v111, v214, v215
    v_cvt_pk_bf16_f32 v112, v216, v217
    v_cvt_pk_bf16_f32 v113, v218, v219
    v_cvt_pk_bf16_f32 v114, v220, v221
    v_cvt_pk_bf16_f32 v115, v222, v223
    ds_write_b128 v140, v[108:111] offset:32768
    ds_write_b128 v140, v[112:115] offset:32896
    v_cvt_pk_bf16_f32 v100, v240, v241
    v_cvt_pk_bf16_f32 v101, v242, v243
    v_cvt_pk_bf16_f32 v102, v244, v245
    v_cvt_pk_bf16_f32 v103, v246, v247
    v_cvt_pk_bf16_f32 v104, v248, v249
    v_cvt_pk_bf16_f32 v105, v250, v251
    v_cvt_pk_bf16_f32 v106, v252, v253
    v_cvt_pk_bf16_f32 v107, v254, v255
    ds_write_b128 v140, v[100:103] offset:16384
    ds_write_b128 v140, v[104:107] offset:16512
    s_mov_b64 exec, 1
    ds_add_u32 v0, v10 offset:16
    s_mov_b64 exec, -1
    s_waitcnt vmcnt(3)
    v_lshlrev_b32 v148, 16, v12
    s_waitcnt vmcnt(2)
    v_lshlrev_b32 v149, 16, v16
    s_waitcnt vmcnt(1)
    v_lshlrev_b32 v150, 16, v20
    s_waitcnt vmcnt(0)
    v_lshlrev_b32 v151, 16, v24
    v_and_b32 v152, 0xffff0000, v12
    v_and_b32 v153, 0xffff0000, v16
    v_and_b32 v154, 0xffff0000, v20
    v_and_b32 v155, 0xffff0000, v24
    v_lshlrev_b32 v156, 16, v14
    v_lshlrev_b32 v157, 16, v18
    v_lshlrev_b32 v158, 16, v22
    v_lshlrev_b32 v159, 16, v26
    v_and_b32 v160, 0xffff0000, v14
    v_and_b32 v161, 0xffff0000, v18
    v_and_b32 v162, 0xffff0000, v22
    v_and_b32 v163, 0xffff0000, v26
    v_mov_b32 v2, 0x3f80
    v_mov_b32 v3, 0x3f800000
    ds_read_b32 v7, v0 offset:16
    s_waitcnt lgkmcnt(0)
    v_readfirstlane_b32 s100, v7
    s_nop 0
    s_cmp_ge_u32 s100, 4
    s_cbranch_scc1 L_sw5x
L_sw5:
    s_sleep 1
    ds_read_b32 v7, v0 offset:16
    s_waitcnt lgkmcnt(0)
    v_readfirstlane_b32 s100, v7
    s_add_u32 s59, s59, 1
    s_cmp_ge_u32 s59, 0x1000000
    s_cbranch_scc1 L_sw5x
    s_cmp_ge_u32 s100, 4
    s_cbranch_scc0 L_sw5
L_sw5x:
    ds_read_b128 v[116:119], v142 offset:0
    ds_read_b128 v[124:127], v144 offset:16384
    ds_read_b128 v[132:135], v146 offset:32768
    ds_read_b128 v[120:123], v142 offset:128
    ds_read_b128 v[128:131], v144 offset:16512
    ds_read_b128 v[136:139], v146 offset:32896
    s_waitcnt lgkmcnt(5)
    v_dot2_f32_bf16 v224, v116, v2, v224
    v_dot2_f32_bf16 v225, v116, v3, v225
    v_dot2_f32_bf16 v226, v117, v2, v226
    v_dot2_f32_bf16 v227, v117, v3, v227
    v_dot2_f32_bf16 v228, v118, v2, v228
    v_dot2_f32_bf16 v229, v118, v3, v229
    v_dot2_f32_bf16 v230, v119, v2, v230
    v_dot2_f32_bf16 v231, v119, v3, v231
    s_waitcnt lgkmcnt(4)
    v_dot2_f32_bf16 v224, v124, v2, v224
    v_dot2_f32_bf16 v225, v124, v3, v225
    v_dot2_f32_bf16 v226, v125, v2, v226
    v_dot2_f32_bf16 v227, v125, v3, v227
    v_dot2_f32_bf16 v228, v126, v2, v228
    v_dot2_f32_bf16 v229, v126, v3, v229
    v_dot2_f32_bf16 v230, v127, v2, v230
    v_dot2_f32_bf16 v231, v127, v3, v231
    s_waitcnt lgkmcnt(3)
    v_dot2_f32_bf16 v224, v132, v2, v224
    v_dot2_f32_bf16 v225, v132, v3, v225
    v_dot2_f32_bf16 v226, v133, v2, v226
    v_dot2_f32_bf16 v227, v133, v3, v227
    v_dot2_f32_bf16 v228, v134, v2, v228
    v_dot2_f32_bf16 v229, v134, v3, v229
    v_dot2_f32_bf16 v230, v135, v2, v230
    v_dot2_f32_bf16 v231, v135, v3, v231
    s_waitcnt lgkmcnt(2)
    v_dot2_f32_bf16 v232, v120, v2, v232
    v_dot2_f32_bf16 v233, v120, v3, v233
    v_dot2_f32_bf16 v234, v121, v2, v234
    v_dot2_f32_bf16 v235, v121, v3, v235
    v_dot2_f32_bf16 v236, v122, v2, v236
    v_dot2_f32_bf16 v237, v122, v3, v237
    v_dot2_f32_bf16 v238, v123, v2, v238
    v_dot2_f32_bf16 v239, v123, v3, v239
    s_waitcnt lgkmcnt(1)
    v_dot2_f32_bf16 v232, v128, v2, v232
    v_dot2_f32_bf16 v233, v128, v3, v233
    v_dot2_f32_bf16 v234, v129, v2, v234
    v_dot2_f32_bf16 v235, v129, v3, v235
    v_dot2_f32_bf16 v236, v130, v2, v236
    v_dot2_f32_bf16 v237, v130, v3, v237
    v_dot2_f32_bf16 v238, v131, v2, v238
    v_dot2_f32_bf16 v239, v131, v3, v239
    s_waitcnt lgkmcnt(0)
    v_dot2_f32_bf16 v232, v136, v2, v232
    v_dot2_f32_bf16 v233, v136, v3, v233
    v_dot2_f32_bf16 v234, v137, v2, v234
    v_dot2_f32_bf16 v235, v137, v3, v235
    v_dot2_f32_bf16 v236, v138, v2, v236
    v_dot2_f32_bf16 v237, v138, v3, v237
    v_dot2_f32_bf16 v238, v139, v2, v238
    v_dot2_f32_bf16 v239, v139, v3, v239
    v_mul_f32 v164, v224, v224
    v_mul_f32 v165, v225, v225
    v_mul_f32 v166, v226, v226
    v_mul_f32 v167, v227, v227
    v_mul_f32 v168, v228, v228
    v_mul_f32 v169, v229, v229
    v_mul_f32 v170, v230, v230
    v_mul_f32 v171, v231, v231
    v_mul_f32 v172, v232, v232
    v_mul_f32 v173, v233, v233
    v_mul_f32 v174, v234, v234
    v_mul_f32 v175, v235, v235
    v_mul_f32 v176, v236, v236
    v_mul_f32 v177, v237, v237
    v_mul_f32 v178, v238, v238
    v_mul_f32 v179, v239, v239
    v_fmaak_f32 v164, v9, v164, 0xc0135761
    v_fmaak_f32 v165, v9, v165, 0xc0135761
    v_fmaak_f32 v166, v9, v166, 0xc0135761
    v_fmaak_f32 v167, v9, v167, 0xc0135761
    v_fmaak_f32 v168, v9, v168, 0xc0135761
    v_fmaak_f32 v169, v9, v169, 0xc0135761
    v_fmaak_f32 v170, v9, v170, 0xc0135761
    v_fmaak_f32 v171, v9, v171, 0xc0135761
    v_fmaak_f32 v172, v9, v172, 0xc0135761
    v_fmaak_f32 v173, v9, v173, 0xc0135761
    v_fmaak_f32 v174, v9, v174, 0xc0135761
    v_fmaak_f32 v175, v9, v175, 0xc0135761
    v_fmaak_f32 v176, v9, v176, 0xc0135761
    v_fmaak_f32 v177, v9, v177, 0xc0135761
    v_fmaak_f32 v178, v9, v178, 0xc0135761
    v_fmaak_f32 v179, v9, v179, 0xc0135761
    v_mul_f32 v164, v164, v224
    v_mul_f32 v165, v165, v225
    v_mul_f32 v166, v166, v226
    v_mul_f32 v167, v167, v227
    v_mul_f32 v168, v168, v228
    v_mul_f32 v169, v169, v229
    v_mul_f32 v170, v170, v230
    v_mul_f32 v171, v171, v231
    v_mul_f32 v172, v172, v232
    v_mul_f32 v173, v173, v233
    v_mul_f32 v174, v174, v234
    v_mul_f32 v175, v175, v235
    v_mul_f32 v176, v176, v236
    v_mul_f32 v177, v177, v237
    v_mul_f32 v178, v178, v238
    v_mul_f32 v179, v179, v239
    v_exp_f32 v164, v164
    v_exp_f32 v165, v165
    v_exp_f32 v166, v166
    v_exp_f32 v167, v167
    v_exp_f32 v168, v168
    v_exp_f32 v169, v169
    v_exp_f32 v170, v170
    v_exp_f32 v171, v171
    v_exp_f32 v172, v172
    v_exp_f32 v173, v173
    v_exp_f32 v174, v174
    v_exp_f32 v175, v175
    v_exp_f32 v176, v176
    v_exp_f32 v177, v177
    v_exp_f32 v178, v178
    v_exp_f32 v179, v179
    v_add_f32 v164, 1.0, v164
    v_add_f32 v165, 1.0, v165
    v_add_f32 v166, 1.0, v166
    v_add_f32 v167, 1.0, v167
    v_add_f32 v168, 1.0, v168
    v_add_f32 v169, 1.0, v169
    v_add_f32 v170, 1.0, v170
    v_add_f32 v171, 1.0, v171
    v_add_f32 v172, 1.0, v172
    v_add_f32 v173, 1.0, v173
    v_add_f32 v174, 1.0, v174
    v_add_f32 v175, 1.0, v175
    v_add_f32 v176, 1.0, v176
    v_add_f32 v177, 1.0, v177
    v_add_f32 v178, 1.0, v178
    v_add_f32 v179, 1.0, v179
    v_rcp_f32 v164, v164
    v_rcp_f32 v165, v165
    v_rcp_f32 v166, v166
    v_rcp_f32 v167, v167
    v_rcp_f32 v168, v168
    v_rcp_f32 v169, v169
    v_rcp_f32 v170, v170
    v_rcp_f32 v171, v171
    v_rcp_f32 v172, v172
    v_rcp_f32 v173, v173
    v_rcp_f32 v174, v174
    v_rcp_f32 v175, v175
    v_rcp_f32 v176, v176
    v_rcp_f32 v177, v177
    v_rcp_f32 v178, v178
    v_rcp_f32 v179, v179
    v_mul_f32 v224, v224, v164
    v_mul_f32 v225, v225, v165
    v_mul_f32 v226, v226, v166
    v_mul_f32 v227, v227, v167
    v_mul_f32 v228, v228, v168
    v_mul_f32 v229, v229, v169
    v_mul_f32 v230, v230, v170
    v_mul_f32 v231, v231, v171
    v_mul_f32 v232, v232, v172
    v_mul_f32 v233, v233, v173
    v_mul_f32 v234, v234, v174
    v_mul_f32 v235, v235, v175
    v_mul_f32 v236, v236, v176
    v_mul_f32 v237, v237, v177
    v_mul_f32 v238, v238, v178
    v_mul_f32 v239, v239, v179
    v_mul_f32 v10, v224, v148
    v_mul_f32 v11, v225, v149
    v_fmac_f32 v10, v226, v150
    v_fmac_f32 v11, v227, v151
    v_fmac_f32 v10, v228, v152
    v_fmac_f32 v11, v229, v153
    v_fmac_f32 v10, v230, v154
    v_fmac_f32 v11, v231, v155
    v_fmac_f32 v10, v232, v156
    v_fmac_f32 v11, v233, v157
    v_fmac_f32 v10, v234, v158
    v_fmac_f32 v11, v235, v159
    v_fmac_f32 v10, v236, v160
    v_fmac_f32 v11, v237, v161
    v_fmac_f32 v10, v238, v162
    v_fmac_f32 v11, v239, v163
    v_add_f32 v10, v10, v11
L_dpre:
    v_mov_b32 v11, v10
    s_nop 1
    v_permlane32_swap_b32 v10, v11
    v_add_f32 v10, v10, v11
    v_min_u32 v12, -2, v10
    s_nop 1
    v_mov_b32_dpp v13, v12 quad_perm:[1,1,1,1] row_mask:0xf bank_mask:0xf bound_ctrl:0
    v_mov_b32_dpp v14, v12 quad_perm:[2,2,2,2] row_mask:0xf bank_mask:0xf bound_ctrl:0
    v_mov_b32_dpp v15, v12 quad_perm:[3,3,3,3] row_mask:0xf bank_mask:0xf bound_ctrl:0
    s_mov_b32 exec_lo, 0x11111111
    s_mov_b32 exec_hi, 0
    s_cmp_eq_u32 s61, 2
    s_cbranch_scc1 L_sn6f
    buffer_store_dwordx4 v[12:15], v8, s[44:47], s60 offen sc1
    s_branch L_sn6d
L_sn6f:
    buffer_store_dwordx4 v[12:15], v8, s[44:47], s60 offen
L_sn6d:
    s_mov_b64 exec, -1
    s_cmp_eq_u32 s48, 0
    s_cbranch_scc0 L_fin
    v_lshlrev_b32 v3, 4, v1
    s_lshl_b32 s55, s2, 10
    buffer_load_dwordx4 v[16:19], v3, s[44:47], s55 offen sc1
L_poll:
    buffer_load_dwordx4 v[20:23], v3, s[44:47], s55 offen sc1
    s_waitcnt vmcnt(1)
    v_max_u32 v4, v16, v17
    v_max3_u32 v4, v4, v18, v19
    v_cmp_eq_u32 vcc, -1, v4
    s_add_u32 s59, s59, 64
    s_nop 3
    s_cbranch_vccz L_gotA
    buffer_load_dwordx4 v[16:19], v3, s[44:47], s55 offen sc1
    s_waitcnt vmcnt(1)
    v_max_u32 v4, v20, v21
    v_max3_u32 v4, v4, v22, v23
    v_cmp_eq_u32 vcc, -1, v4
    s_cmp_ge_u32 s59, 0x1000000
    s_cbranch_scc1 L_gotB
    s_nop 2
    s_cbranch_vccnz L_poll
L_gotB:
    v_mov_b32 v12, v20
    v_mov_b32 v13, v21
    v_mov_b32 v14, v22
    v_mov_b32 v15, v23
    s_branch L_pollx
L_gotA:
    v_mov_b32 v12, v16
    v_mov_b32 v13, v17
    v_mov_b32 v14, v18
    v_mov_b32 v15, v19
L_pollx:
    s_nop 1
    v_add_f32_dpp v12, v12, v12 row_ror:4 row_mask:0xf bank_mask:0xf bound_ctrl:0
    v_add_f32_dpp v13, v13, v13 row_ror:4 row_mask:0xf bank_mask:0xf bound_ctrl:0
    v_add_f32_dpp v14, v14, v14 row_ror:4 row_mask:0xf bank_mask:0xf bound_ctrl:0
    v_add_f32_dpp v15, v15, v15 row_ror:4 row_mask:0xf bank_mask:0xf bound_ctrl:0
    v_add_f32_dpp v12, v12, v12 row_ror:8 row_mask:0xf bank_mask:0xf bound_ctrl:0
    v_add_f32_dpp v13, v13, v13 row_ror:8 row_mask:0xf bank_mask:0xf bound_ctrl:0
    v_add_f32_dpp v14, v14, v14 row_ror:8 row_mask:0xf bank_mask:0xf bound_ctrl:0
    v_add_f32_dpp v15, v15, v15 row_ror:8 row_mask:0xf bank_mask:0xf bound_ctrl:0
    v_mov_b32 v24, v12
    v_mov_b32 v25, v13
    v_mov_b32 v26, v14
    v_mov_b32 v27, v15
    v_permlane16_swap_b32 v12, v24
    v_permlane16_swap_b32 v13, v25
    v_permlane16_swap_b32 v14, v26
    v_permlane16_swap_b32 v15, v27
    v_add_f32 v12, v12, v24
    v_add_f32 v13, v13, v25
    v_add_f32 v14, v14, v26
    v_add_f32 v15, v15, v27
    v_mov_b32 v24, v12
    v_mov_b32 v25, v13
    v_mov_b32 v26, v14
    v_mov_b32 v27, v15
    v_permlane32_swap_b32 v12, v24
    v_permlane32_swap_b32 v13, v25
    v_permlane32_swap_b32 v14, v26
    v_permlane32_swap_b32 v15, v27
    v_add_f32 v12, v12, v24
    v_add_f32 v13, v13, v25
    v_add_f32 v14, v14, v26
    v_add_f32 v15, v15, v27
    v_cvt_pk_bf16_f32 v12, v12, v13
    v_cvt_pk_bf16_f32 v13, v14, v15
    v_lshlrev_b32 v3, 3, v1
    s_lshl_b32 s55, s2, 5
    s_mov_b64 exec, 0xf
    buffer_store_dwordx2 v[12:13], v3, s[36:39], s55 offen
    s_mov_b64 exec, -1
    s_branch L_fin
L_w4:
    v_bfe_u32 v255, v1, 3, 1
    v_mul_u32_u24 v255, 13, v255
    v_lshrrev_b32 v247, 4, v1
    v_add_u32 v255, v255, v247
    v_and_b32 v247, 7, v1
    v_lshl_add_u32 v255, v255, 6, v247
    v_lshlrev_b32 v255, 9, v255
    s_lshr_b32 s84, s51, 2
    s_lshl_b32 s84, s84, 12
    s_lshl_b32 s101, s49, 7
    s_add_u32 s84, s84, s101
    s_mov_b64 exec, 0xf
    buffer_load_dword v249, v137, s[32:35], 0 offen
    s_mov_b64 exec, -1
    v_mov_b32 v202, -1
    v_mov_b32 v203, -1
    v_mov_b32 v204, -1
    v_mov_b32 v205, -1
    s_lshl_b32 s55, s2, 10
    buffer_store_dwordx4 v[202:205], v92, s[44:47], s55 offen sc1
    s_lshl_b32 s55, s2, 5
    s_mov_b64 exec, 1
    buffer_load_dword v248, v92, s[36:39], s55 offen
    s_mov_b64 exec, -1
    s_lshr_b32 s3, s94, 4
    s_and_b32 s3, s3, 64
    v_xor_b32 v32, s3, v96
    v_add_u32 v32, s94, v32
    v_xor_b32 v37, 64, v32
    s_lshr_b32 s3, s94, 3
    v_add_u32 v42, s3, v97
    s_lshr_b32 s3, s94, 6
    v_add_u32 v47, s3, v98
    v_cmp_gt_u32 s[98:99], 8, v102
    v_cmp_eq_u32 vcc, 8, v102
    v_mov_b32 v100, 0x3c803c80
    s_nop 0
    v_cndmask_b32 v100, 0, v100, vcc
    s_waitcnt vmcnt(7)
    s_barrier
    ds_read_b64_tr_b16 v[104:105], v101 offset:0
    ds_read_b64_tr_b16 v[106:107], v101 offset:64
    ds_read_b64_tr_b16 v[108:109], v101 offset:512
    ds_read_b64_tr_b16 v[110:111], v101 offset:576
    ds_read2_b32 v[64:65], v7 offset0:0 offset1:1
    ds_read2_b32 v[66:67], v7 offset0:2 offset1:3
    ds_read2_b32 v[68:69], v7 offset0:4 offset1:5
    ds_read2_b32 v[70:71], v7 offset0:6 offset1:7
    ds_read2_b32 v[72:73], v7 offset0:8 offset1:9
    ds_read2_b32 v[74:75], v7 offset0:10 offset1:11
    ds_read_b32 v76, v7 offset:48
    ds_read_u16 v12, v250 offset:0
    ds_read_u16 v13, v250 offset:26
    ds_read_u16 v14, v250 offset:52
    ds_read_u16 v15, v250 offset:78
    ds_read_u16 v16, v250 offset:104
    ds_read_u16 v17, v250 offset:130
    ds_read_u16 v18, v250 offset:156
    ds_read_u16 v19, v250 offset:182
    ds_read_u16 v20, v250 offset:208
    ds_read_u16 v21, v250 offset:234
    ds_read_u16 v22, v250 offset:260
    ds_read_u16 v23, v250 offset:286
    ds_read_u16 v166, v250 offset:312
    ds_read_u16 v24, v9 offset:0
    ds_read_u16 v25, v9 offset:52
    ds_read_u16 v26, v9 offset:104
    ds_read_u16 v27, v9 offset:156
    ds_read_u16 v28, v9 offset:208
    ds_read_u16 v29, v9 offset:260
    ds_read_u16 v30, v9 offset:312
    ds_read_u16 v31, v9 offset:364
    s_waitcnt lgkmcnt(15)
    v_cndmask_b32 v104, v100, v104, s[98:99]
    v_cndmask_b32 v105, v100, v105, s[98:99]
    v_cndmask_b32 v106, v100, v106, s[98:99]
    v_cndmask_b32 v107, v100, v107, s[98:99]
    v_cndmask_b32 v108, v100, v108, s[98:99]
    v_cndmask_b32 v109, v100, v109, s[98:99]
    v_cndmask_b32 v110, v100, v110, s[98:99]
    v_cndmask_b32 v111, v100, v111, s[98:99]
    s_waitcnt vmcnt(3)
    ds_read_b128 v[112:115], v32 offset:0
    ds_read_b128 v[116:119], v37 offset:0
    ds_read_b128 v[120:123], v32 offset:2048
    ds_read_b128 v[124:127], v37 offset:2048
    v_lshlrev_b32 v0, 3, v64
    v_bitop3_b32 v0, v0, s58, v103 bitop3:0x28
    v_lshl_or_b32 v168, v64, 7, v0
    v_lshl_add_u32 v234, v64, 4, s75
    v_lshl_add_u32 v218, v64, 1, s76
    v_lshlrev_b32 v0, 3, v65
    v_bitop3_b32 v0, v0, s58, v103 bitop3:0x28
    v_lshl_or_b32 v169, v65, 7, v0
    v_lshl_add_u32 v235, v65, 4, s75
    v_lshl_add_u32 v219, v65, 1, s76
    v_lshlrev_b32 v0, 3, v66
    v_bitop3_b32 v0, v0, s58, v103 bitop3:0x28
    v_lshl_or_b32 v170, v66, 7, v0
    v_lshl_add_u32 v236, v66, 4, s75
    v_lshl_add_u32 v220, v66, 1, s76
    v_lshlrev_b32 v0, 3, v67
    v_bitop3_b32 v0, v0, s58, v103 bitop3:0x28
    v_lshl_or_b32 v171, v67, 7, v0
    v_lshl_add_u32 v237, v67, 4, s75
    v_lshl_add_u32 v221, v67, 1, s76
    v_lshlrev_b32 v0, 3, v68
    v_bitop3_b32 v0, v0, s58, v103 bitop3:0x28
    v_lshl_or_b32 v172, v68, 7, v0
    v_lshl_add_u32 v238, v68, 4, s75
    v_lshl_add_u32 v222, v68, 1, s76
    v_lshlrev_b32 v0, 3, v69
    v_bitop3_b32 v0, v0, s58, v103 bitop3:0x28
    v_lshl_or_b32 v173, v69, 7, v0
    v_lshl_add_u32 v239, v69, 4, s75
    v_lshl_add_u32 v223, v69, 1, s76
    s_waitcnt lgkmcnt(3)
    v_mfma_f32_16x16x32_bf16 v[128:131], v[104:107], v[112:115], 0
    s_waitcnt lgkmcnt(1)
    v_mfma_f32_16x16x32_bf16 v[132:135], v[104:107], v[120:123], 0
    v_mfma_f32_16x16x32_bf16 v[128:131], v[108:111], v[116:119], v[128:131]
    s_waitcnt lgkmcnt(0)
    v_mfma_f32_16x16x32_bf16 v[132:135], v[108:111], v[124:127], v[132:135]
    v_lshlrev_b32 v0, 3, v70
    v_bitop3_b32 v0, v0, s58, v103 bitop3:0x28
    v_lshl_or_b32 v174, v70, 7, v0
    v_lshl_add_u32 v240, v70, 4, s75
    v_lshl_add_u32 v224, v70, 1, s76
    v_lshlrev_b32 v0, 3, v71
    v_bitop3_b32 v0, v0, s58, v103 bitop3:0x28
    v_lshl_or_b32 v175, v71, 7, v0
    v_lshl_add_u32 v241, v71, 4, s75
    v_lshl_add_u32 v225, v71, 1, s76
    v_lshlrev_b32 v0, 3, v72
    v_bitop3_b32 v0, v0, s58, v103 bitop3:0x28
    v_lshl_or_b32 v176, v72, 7, v0
    v_lshl_add_u32 v242, v72, 4, s75
    v_lshl_add_u32 v226, v72, 1, s76
    v_lshlrev_b32 v0, 3, v73
    v_bitop3_b32 v0, v0, s58, v103 bitop3:0x28
    v_lshl_or_b32 v177, v73, 7, v0
    v_lshl_add_u32 v243, v73, 4, s75
    v_lshl_add_u32 v227, v73, 1, s76
    v_lshlrev_b32 v0, 3, v74
    v_bitop3_b32 v0, v0, s58, v103 bitop3:0x28
    v_lshl_or_b32 v178, v74, 7, v0
    v_lshl_add_u32 v244, v74, 4, s75
    v_lshl_add_u32 v228, v74, 1, s76
    v_lshlrev_b32 v0, 3, v75
    v_bitop3_b32 v0, v0, s58, v103 bitop3:0x28
    v_lshl_or_b32 v179, v75, 7, v0
    v_lshl_add_u32 v245, v75, 4, s75
    v_lshl_add_u32 v229, v75, 1, s76
    v_lshlrev_b32 v0, 3, v76
    v_bitop3_b32 v0, v0, s58, v103 bitop3:0x28
    v_lshl_or_b32 v180, v76, 7, v0
    v_lshl_add_u32 v246, v76, 4, s75
    v_lshl_add_u32 v230, v76, 1, s76
    v_cvt_pk_bf16_f32 v140, v128, v129
    v_cvt_pk_bf16_f32 v142, v132, v133
    v_cvt_pk_bf16_f32 v141, v130, v131
    v_cvt_pk_bf16_f32 v143, v134, v135
    v_permlane32_swap_b32 v140, v142
    s_nop 0
    v_permlane32_swap_b32 v141, v143
    v_lshl_or_b32 v160, v13, 16, v12
    v_lshl_or_b32 v161, v15, 16, v14
    v_lshl_or_b32 v162, v17, 16, v16
    v_lshl_or_b32 v163, v19, 16, v18
    v_lshl_or_b32 v164, v21, 16, v20
    v_lshl_or_b32 v165, v23, 16, v22
    v_lshl_or_b32 v186, v25, 16, v24
    v_lshl_or_b32 v187, v27, 16, v26
    v_lshl_or_b32 v188, v29, 16, v28
    v_lshl_or_b32 v189, v31, 16, v30
    s_mov_b32 exec_lo, 0xffff
    s_mov_b32 exec_hi, 0xffff
    ds_write_b16 v47, v142
    s_mov_b64 exec, -1
    ds_write_b64 v42, v[140:141]
    s_waitcnt lgkmcnt(0)
    s_mov_b32 s84, 0
    s_branch L_cB3
L_cross:
    s_setprio 1
    s_sub_u32 s57, s48, 4
    s_mul_i32 s55, s57, 3328
    s_add_u32 s55, s55, 146000
    v_add_u32 v7, s55, v7
    v_lshrrev_b32 v8, 3, v5
    v_bfe_u32 v9, v5, 2, 1
    v_and_b32 v10, 3, v5
    v_lshl_add_u32 v11, v8, 2, v10
    v_lshl_add_u32 v3, v9, 3, v11
    v_mul_u32_u24 v250, 169, v6
    v_add_u32 v250, v250, v3
    v_lshlrev_b32 v250, 1, v250
    v_add_u32 v250, 160336, v250
    v_cmp_gt_u32 vcc, 13, v3
    v_cmp_gt_u32 s[98:99], 16, v5
    s_nop 0
    s_and_b64 vcc, vcc, s[98:99]
    v_mov_b32 v3, 161016
    v_cndmask_b32 v250, v3, v250, vcc
    v_mul_u32_u24 v3, 13, v9
    v_add_u32 v3, v3, v11
    v_mul_u32_u24 v8, 208, v6
    v_add_u32 v9, v8, v3
    v_lshlrev_b32 v9, 1, v9
    v_add_u32 v9, 161360, v9
    v_min_u32 v3, 25, v3
    v_mul_u32_u24 v3, 416, v3
    v_add_u32 v3, v3, v8
    v_cmp_gt_u32 vcc, 6032, v3
    v_mov_b32 v10, 139968
    v_mov_b32 v11, 157264
    v_cndmask_b32 v10, v10, v11, vcc
    v_add_u32 v4, v10, v3
    v_add_u32 v3, 146000, v3
    v_mov_b32 v251, 163776
    v_mov_b32 v252, 1
    s_getreg_b32 s82, hwreg(HW_REG_XCC_ID, 0, 4)
    s_mul_i32 s83, s82, s82
    s_lshl_b32 s83, s83, 16
    s_lshl_b32 s82, s82, 8
    s_add_u32 s82, s82, s83
    s_add_u32 s82, s82, 1
    s_lshl_b32 s83, s82, 3
    v_mov_b32 v167, 0
    s_lshl_b32 s58, s52, 4
    s_lshl_b32 s55, s53, 3
    v_mov_b32 v254, s55
    s_mov_b32 s60, 0x05040100
    s_mov_b32 s61, 0x07060302
    s_mov_b32 s73, 0x0c0c0100
    s_mov_b32 s74, 0x0c0c0302
    s_mov_b32 s75, 128000
    s_mov_b32 s76, 144000
    s_cmp_eq_u32 s48, 4
    s_cbranch_scc1 L_w4
    s_lshr_b32 s3, s94, 4
    s_and_b32 s3, s3, 64
    v_xor_b32 v32, s3, v96
    v_add_u32 v32, s94, v32
    v_xor_b32 v37, 64, v32
    s_lshr_b32 s3, s94, 3
    v_add_u32 v42, s3, v97
    s_lshr_b32 s3, s94, 6
    v_add_u32 v47, s3, v98
    s_lshr_b32 s3, s95, 4
    s_and_b32 s3, s3, 64
    v_xor_b32 v33, s3, v96
    v_add_u32 v33, s95, v33
    v_xor_b32 v38, 64, v33
    v_xor_b32 v54, s3, v93
    v_xor_b32 v55, 64, v54
    s_lshr_b32 s3, s95, 3
    v_add_u32 v43, s3, v97
    s_lshr_b32 s3, s95, 6
    v_add_u32 v48, s3, v98
    s_lshr_b32 s3, s96, 4
    s_and_b32 s3, s3, 64
    v_xor_b32 v34, s3, v96
    v_add_u32 v34, s96, v34
    v_xor_b32 v39, 64, v34
    v_xor_b32 v56, s3, v93
    v_xor_b32 v57, 64, v56
    s_lshr_b32 s3, s96, 3
    v_add_u32 v44, s3, v97
    s_lshr_b32 s3, s96, 6
    v_add_u32 v49, s3, v98
    s_lshr_b32 s3, s97, 4
    s_and_b32 s3, s3, 64
    v_xor_b32 v35, s3, v96
    v_add_u32 v35, s97, v35
    v_xor_b32 v40, 64, v35
    v_xor_b32 v58, s3, v93
    v_xor_b32 v59, 64, v58
    s_lshr_b32 s3, s97, 3
    v_add_u32 v45, s3, v97
    s_lshr_b32 s3, s97, 6
    v_add_u32 v50, s3, v98
    s_lshr_b32 s3, s85, 4
    s_and_b32 s3, s3, 64
    v_xor_b32 v36, s3, v96
    v_add_u32 v36, s85, v36
    v_xor_b32 v41, 64, v36
    v_xor_b32 v60, s3, v93
    v_xor_b32 v61, 64, v60
    s_lshr_b32 s3, s85, 3
    v_add_u32 v46, s3, v97
    s_lshr_b32 s3, s85, 6
    v_add_u32 v51, s3, v98
    v_cmp_gt_u32 s[98:99], 8, v102
    v_cmp_eq_u32 vcc, 8, v102
    v_mov_b32 v100, 0x3c803c80
    s_nop 0
    v_cndmask_b32 v100, 0, v100, vcc
    s_mov_b32 m0, s95
    s_nop 0
    buffer_load_dwordx4 v54, s[8:11], s95 offen offset:0 lds
    buffer_load_dwordx4 v55, s[8:11], s95 offen offset:1024 lds
    buffer_load_dwordx4 v54, s[8:11], s95 offen offset:2048 lds
    buffer_load_dwordx4 v55, s[8:11], s95 offen offset:3072 lds
    s_waitcnt vmcnt(8)
    s_barrier
    s_mov_b32 m0, s96
    s_nop 0
    buffer_load_dwordx4 v56, s[8:11], s96 offen offset:0 lds
    ds_read_b64_tr_b16 v[104:105], v101 offset:0
    ds_read_b64_tr_b16 v[106:107], v101 offset:64
    ds_read_b64_tr_b16 v[108:109], v101 offset:512
    ds_read_b64_tr_b16 v[110:111], v101 offset:576
    ds_read2_b32 v[64:65], v7 offset0:0 offset1:1
    ds_read2_b32 v[66:67], v7 offset0:2 offset1:3
    ds_read2_b32 v[68:69], v7 offset0:4 offset1:5
    buffer_load_dwordx4 v57, s[8:11], s96 offen offset:1024 lds
    ds_read2_b32 v[70:71], v7 offset0:6 offset1:7
    ds_read2_b32 v[72:73], v7 offset0:8 offset1:9
    ds_read2_b32 v[74:75], v7 offset0:10 offset1:11
    ds_read_b32 v76, v7 offset:48
    ds_read_u16 v12, v250 offset:0
    ds_read_u16 v13, v250 offset:26
    ds_read_u16 v14, v250 offset:52
    buffer_load_dwordx4 v56, s[8:11], s96 offen offset:2048 lds
    ds_read_u16 v15, v250 offset:78
    ds_read_u16 v16, v250 offset:104
    ds_read_u16 v17, v250 offset:130
    ds_read_u16 v18, v250 offset:156
    ds_read_u16 v19, v250 offset:182
    ds_read_u16 v20, v250 offset:208
    buffer_load_dwordx4 v57, s[8:11], s96 offen offset:3072 lds
    ds_read_u16 v21, v250 offset:234
    ds_read_u16 v22, v250 offset:260
    ds_read_u16 v23, v250 offset:286
    ds_read_u16 v166, v250 offset:312
    ds_read_u16 v24, v9 offset:0
    ds_read_u16 v25, v9 offset:52
    ds_read_u16 v26, v9 offset:104
    s_mov_b32 m0, s97
    s_nop 0
    buffer_load_dwordx4 v58, s[8:11], s97 offen offset:0 lds
    ds_read_u16 v27, v9 offset:156
    ds_read_u16 v28, v9 offset:208
    ds_read_u16 v29, v9 offset:260
    ds_read_u16 v30, v9 offset:312
    ds_read_u16 v31, v9 offset:364
    s_waitcnt lgkmcnt(15)
    v_cndmask_b32 v104, v100, v104, s[98:99]
    v_cndmask_b32 v105, v100, v105, s[98:99]
    buffer_load_dwordx4 v59, s[8:11], s97 offen offset:1024 lds
    v_cndmask_b32 v106, v100, v106, s[98:99]
    v_cndmask_b32 v107, v100, v107, s[98:99]
    v_cndmask_b32 v108, v100, v108, s[98:99]
    v_cndmask_b32 v109, v100, v109, s[98:99]
    v_cndmask_b32 v110, v100, v110, s[98:99]
    v_cndmask_b32 v111, v100, v111, s[98:99]
    buffer_load_dwordx4 v58, s[8:11], s97 offen offset:2048 lds
    s_waitcnt vmcnt(11)
    ds_read_b128 v[112:115], v32 offset:0
    ds_read_b128 v[116:119], v37 offset:0
    ds_read_b128 v[120:123], v32 offset:2048
    ds_read_b128 v[124:127], v37 offset:2048
    v_lshlrev_b32 v0, 3, v64
    v_bitop3_b32 v0, v0, s58, v103 bitop3:0x28
    buffer_load_dwordx4 v59, s[8:11], s97 offen offset:3072 lds
    v_lshl_or_b32 v168, v64, 7, v0
    v_lshl_add_u32 v234, v64, 4, s75
    v_lshl_add_u32 v218, v64, 1, s76
    v_lshlrev_b32 v0, 3, v65
    v_bitop3_b32 v0, v0, s58, v103 bitop3:0x28
    v_lshl_or_b32 v169, v65, 7, v0
    v_lshl_add_u32 v235, v65, 4, s75
    s_mov_b32 m0, s85
    s_nop 0
    buffer_load_dwordx4 v60, s[8:11], s85 offen offset:0 lds
    v_lshl_add_u32 v219, v65, 1, s76
    v_lshlrev_b32 v0, 3, v66
    v_bitop3_b32 v0, v0, s58, v103 bitop3:0x28
    v_lshl_or_b32 v170, v66, 7, v0
    v_lshl_add_u32 v236, v66, 4, s75
    v_lshl_add_u32 v220, v66, 1, s76
    s_waitcnt lgkmcnt(3)
    v_mfma_f32_16x16x32_bf16 v[128:131], v[104:107], v[112:115], 0
    buffer_load_dwordx4 v61, s[8:11], s85 offen offset:1024 lds
    s_waitcnt lgkmcnt(1)
    v_mfma_f32_16x16x32_bf16 v[132:135], v[104:107], v[120:123], 0
    v_mfma_f32_16x16x32_bf16 v[128:131], v[108:111], v[116:119], v[128:131]
    s_waitcnt lgkmcnt(0)
    v_mfma_f32_16x16x32_bf16 v[132:135], v[108:111], v[124:127], v[132:135]
    v_lshlrev_b32 v0, 3, v67
    v_bitop3_b32 v0, v0, s58, v103 bitop3:0x28
    v_lshl_or_b32 v171, v67, 7, v0
    v_lshl_add_u32 v237, v67, 4, s75
    buffer_load_dwordx4 v60, s[8:11], s85 offen offset:2048 lds
    v_lshl_add_u32 v221, v67, 1, s76
    v_lshlrev_b32 v0, 3, v68
    v_bitop3_b32 v0, v0, s58, v103 bitop3:0x28
    v_lshl_or_b32 v172, v68, 7, v0
    v_lshl_add_u32 v238, v68, 4, s75
    v_lshl_add_u32 v222, v68, 1, s76
    buffer_load_dwordx4 v61, s[8:11], s85 offen offset:3072 lds
    v_lshlrev_b32 v0, 3, v69
    v_bitop3_b32 v0, v0, s58, v103 bitop3:0x28
    v_lshl_or_b32 v173, v69, 7, v0
    v_lshl_add_u32 v239, v69, 4, s75
    v_lshl_add_u32 v223, v69, 1, s76
    v_cvt_pk_bf16_f32 v140, v128, v129
    v_cvt_pk_bf16_f32 v142, v132, v133
    v_cvt_pk_bf16_f32 v141, v130, v131
    v_cvt_pk_bf16_f32 v143, v134, v135
    v_permlane32_swap_b32 v140, v142
    s_nop 0
    v_permlane32_swap_b32 v141, v143
    v_lshl_or_b32 v160, v13, 16, v12
    v_lshl_or_b32 v161, v15, 16, v14
    v_lshl_or_b32 v162, v17, 16, v16
    v_lshl_or_b32 v163, v19, 16, v18
    v_lshl_or_b32 v164, v21, 16, v20
    v_lshl_or_b32 v165, v23, 16, v22
    v_lshl_or_b32 v186, v25, 16, v24
    v_lshl_or_b32 v187, v27, 16, v26
    v_lshl_or_b32 v188, v29, 16, v28
    v_lshl_or_b32 v189, v31, 16, v30
    s_waitcnt vmcnt(12)
    ds_read_b128 v[112:115], v33 offset:0
    ds_read_b128 v[116:119], v38 offset:0
    ds_read_b128 v[120:123], v33 offset:2048
    ds_read_b128 v[124:127], v38 offset:2048
    v_lshlrev_b32 v0, 3, v70
    v_bitop3_b32 v0, v0, s58, v103 bitop3:0x28
    v_lshl_or_b32 v174, v70, 7, v0
    v_lshl_add_u32 v240, v70, 4, s75
    v_lshl_add_u32 v224, v70, 1, s76
    v_lshlrev_b32 v0, 3, v71
    v_bitop3_b32 v0, v0, s58, v103 bitop3:0x28
    v_lshl_or_b32 v175, v71, 7, v0
    v_lshl_add_u32 v241, v71, 4, s75
    v_lshl_add_u32 v225, v71, 1, s76
    v_lshlrev_b32 v0, 3, v72
    v_bitop3_b32 v0, v0, s58, v103 bitop3:0x28
    v_lshl_or_b32 v176, v72, 7, v0
    v_lshl_add_u32 v242, v72, 4, s75
    v_lshl_add_u32 v226, v72, 1, s76
    s_waitcnt lgkmcnt(3)
    v_mfma_f32_16x16x32_bf16 v[128:131], v[104:107], v[112:115], 0
    s_waitcnt lgkmcnt(1)
    v_mfma_f32_16x16x32_bf16 v[132:135], v[104:107], v[120:123], 0
    v_mfma_f32_16x16x32_bf16 v[128:131], v[108:111], v[116:119], v[128:131]
    s_waitcnt lgkmcnt(0)
    v_mfma_f32_16x16x32_bf16 v[132:135], v[108:111], v[124:127], v[132:135]
    v_lshlrev_b32 v0, 3, v73
    v_bitop3_b32 v0, v0, s58, v103 bitop3:0x28
    v_lshl_or_b32 v177, v73, 7, v0
    v_lshl_add_u32 v243, v73, 4, s75
    v_lshl_add_u32 v227, v73, 1, s76
    v_lshlrev_b32 v0, 3, v74
    v_bitop3_b32 v0, v0, s58, v103 bitop3:0x28
    v_lshl_or_b32 v178, v74, 7, v0
    v_lshl_add_u32 v244, v74, 4, s75
    v_lshl_add_u32 v228, v74, 1, s76
    v_lshlrev_b32 v0, 3, v75
    v_bitop3_b32 v0, v0, s58, v103 bitop3:0x28
    v_lshl_or_b32 v179, v75, 7, v0
    v_lshl_add_u32 v245, v75, 4, s75
    v_lshl_add_u32 v229, v75, 1, s76
    v_lshlrev_b32 v0, 3, v76
    v_bitop3_b32 v0, v0, s58, v103 bitop3:0x28
    v_lshl_or_b32 v180, v76, 7, v0
    v_lshl_add_u32 v246, v76, 4, s75
    v_lshl_add_u32 v230, v76, 1, s76
    v_cvt_pk_bf16_f32 v144, v128, v129
    v_cvt_pk_bf16_f32 v146, v132, v133
    v_cvt_pk_bf16_f32 v145, v130, v131
    v_cvt_pk_bf16_f32 v147, v134, v135
    v_permlane32_swap_b32 v144, v146
    s_nop 0
    v_permlane32_swap_b32 v145, v147
    s_waitcnt vmcnt(8)
    ds_read_b128 v[112:115], v34 offset:0
    ds_read_b128 v[116:119], v39 offset:0
    ds_read_b128 v[120:123], v34 offset:2048
    ds_read_b128 v[124:127], v39 offset:2048
    s_mov_b32 exec_lo, 0xffff
    s_mov_b32 exec_hi, 0xffff
    ds_write_b16 v47, v142
    ds_write_b16 v48, v146
    s_mov_b64 exec, -1
    ds_write_b64 v42, v[140:141]
    ds_write_b64 v43, v[144:145]
    s_waitcnt lgkmcnt(7)
    v_mfma_f32_16x16x32_bf16 v[128:131], v[104:107], v[112:115], 0
    s_waitcnt lgkmcnt(5)
    v_mfma_f32_16x16x32_bf16 v[132:135], v[104:107], v[120:123], 0
    v_mfma_f32_16x16x32_bf16 v[128:131], v[108:111], v[116:119], v[128:131]
    s_waitcnt lgkmcnt(4)
    v_mfma_f32_16x16x32_bf16 v[132:135], v[108:111], v[124:127], v[132:135]
    s_nop 5
    v_cvt_pk_bf16_f32 v148, v128, v129
    s_nop 0
    v_cvt_pk_bf16_f32 v150, v132, v133
    v_cvt_pk_bf16_f32 v149, v130, v131
    v_cvt_pk_bf16_f32 v151, v134, v135
    v_permlane32_swap_b32 v148, v150
    s_nop 0
    v_permlane32_swap_b32 v149, v151
    s_waitcnt vmcnt(4)
    ds_read_b128 v[112:115], v35 offset:0
    ds_read_b128 v[116:119], v40 offset:0
    ds_read_b128 v[120:123], v35 offset:2048
    ds_read_b128 v[124:127], v40 offset:2048
    s_mov_b32 exec_lo, 0xffff
    s_mov_b32 exec_hi, 0xffff
    ds_write_b16 v49, v150
    s_mov_b64 exec, -1
    ds_write_b64 v44, v[148:149]
    s_waitcnt lgkmcnt(5)
    v_mfma_f32_16x16x32_bf16 v[128:131], v[104:107], v[112:115], 0
    s_waitcnt lgkmcnt(3)
    v_mfma_f32_16x16x32_bf16 v[132:135], v[104:107], v[120:123], 0
    v_mfma_f32_16x16x32_bf16 v[128:131], v[108:111], v[116:119], v[128:131]
    s_waitcnt lgkmcnt(2)
    v_mfma_f32_16x16x32_bf16 v[132:135], v[108:111], v[124:127], v[132:135]
    s_nop 5
    v_cvt_pk_bf16_f32 v152, v128, v129
    s_nop 0
    v_cvt_pk_bf16_f32 v154, v132, v133
    v_cvt_pk_bf16_f32 v153, v130, v131
    v_cvt_pk_bf16_f32 v155, v134, v135
    v_permlane32_swap_b32 v152, v154
    s_nop 0
    v_permlane32_swap_b32 v153, v155
    s_waitcnt vmcnt(0)
    ds_read_b128 v[112:115], v36 offset:0
    ds_read_b128 v[116:119], v41 offset:0
    ds_read_b128 v[120:123], v36 offset:2048
    ds_read_b128 v[124:127], v41 offset:2048
    s_mov_b32 exec_lo, 0xffff
    s_mov_b32 exec_hi, 0xffff
    ds_write_b16 v50, v154
    s_mov_b64 exec, -1
    ds_write_b64 v45, v[152:153]
    s_waitcnt lgkmcnt(5)
    v_mfma_f32_16x16x32_bf16 v[128:131], v[104:107], v[112:115], 0
    s_waitcnt lgkmcnt(3)
    v_mfma_f32_16x16x32_bf16 v[132:135], v[104:107], v[120:123], 0
    v_mfma_f32_16x16x32_bf16 v[128:131], v[108:111], v[116:119], v[128:131]
    s_waitcnt lgkmcnt(2)
    v_mfma_f32_16x16x32_bf16 v[132:135], v[108:111], v[124:127], v[132:135]
    s_nop 5
    v_cvt_pk_bf16_f32 v156, v128, v129
    s_nop 0
    v_cvt_pk_bf16_f32 v158, v132, v133
    v_cvt_pk_bf16_f32 v157, v130, v131
    v_cvt_pk_bf16_f32 v159, v134, v135
    v_permlane32_swap_b32 v156, v158
    s_nop 0
    v_permlane32_swap_b32 v157, v159
    s_mov_b32 exec_lo, 0xffff
    s_mov_b32 exec_hi, 0xffff
    ds_write_b16 v51, v158
    s_mov_b64 exec, -1
    ds_write_b64 v46, v[156:157]
    s_waitcnt lgkmcnt(0)
L_cB3:
    s_barrier
    s_setprio 0
    ds_read_u16 v64, v218
    ds_read_u16 v65, v219
    ds_read_u16 v66, v220
    ds_read_u16 v67, v221
    ds_read_u16 v68, v222
    ds_read_u16 v69, v223
    ds_read_u16 v70, v224
    ds_read_u16 v71, v225
    ds_read_u16 v72, v226
    ds_read_u16 v73, v227
    ds_read_u16 v74, v228
    ds_read_u16 v75, v229
    ds_read_u16 v200, v230
    v_mov_b32 v201, 0
    v_mov_b32 v9, 0xbdd2d3e8
    s_cmp_eq_u32 s48, 4
    s_cbranch_scc0 L_rdy1
    s_waitcnt vmcnt(0)
    v_mov_b32 v5, s82
    s_mov_b64 exec, 1
    buffer_atomic_add v5, v254, s[40:43], 0 offen
    s_mov_b64 exec, -1
L_rdy1:
    ds_read_b128 v[12:15], v168
    ds_read_b128 v[16:19], v169
    s_lshl_b32 s79, s57, 11
    s_lshl_b32 s56, s53, 13
    s_add_u32 s79, s79, s56
    s_lshl_b32 s56, s54, 6
    s_add_u32 s79, s79, s56
    v_bfe_u32 v7, v1, 4, 1
    v_and_b32 v8, 15, v1
    v_lshlrev_b32 v8, 2, v8
    v_lshl_add_u32 v8, v7, 10, v8
    s_waitcnt lgkmcnt(13)
    v_lshl_or_b32 v194, v65, 16, v64
    s_waitcnt lgkmcnt(11)
    v_lshl_or_b32 v195, v67, 16, v66
    s_waitcnt lgkmcnt(9)
    v_lshl_or_b32 v196, v69, 16, v68
    s_waitcnt lgkmcnt(7)
    v_lshl_or_b32 v197, v71, 16, v70
    s_waitcnt lgkmcnt(5)
    v_lshl_or_b32 v198, v73, 16, v72
    s_waitcnt lgkmcnt(3)
    v_lshl_or_b32 v199, v75, 16, v74
    v_mfma_f32_32x32x16_bf16 v[202:217], v[160:163], v[194:197], 0
    s_waitcnt lgkmcnt(2)
    v_mfma_f32_32x32x16_bf16 v[202:217], v[164:167], v[198:201], v[202:217]
    ds_read_b128 v[20:23], v170
    ds_read_b128 v[24:27], v171
    ds_read_b128 v[28:31], v172
    ds_read_b128 v[32:35], v173
    ds_read_b128 v[36:39], v174
    ds_read_b128 v[40:43], v175
    s_mov_b32 s81, 0xbf317218
    s_nop 4
    v_mul_f32 v64, v202, v202
    v_mul_f32 v65, v203, v203
    v_mul_f32 v66, v204, v204
    v_mul_f32 v67, v205, v205
    v_mul_f32 v68, v206, v206
    v_mul_f32 v69, v207, v207
    v_mul_f32 v70, v208, v208
    v_mul_f32 v71, v209, v209
    v_fmaak_f32 v64, v9, v64, 0xc0135761
    ds_read_b128 v[44:47], v176
    v_fmaak_f32 v65, v9, v65, 0xc0135761
    v_fmaak_f32 v66, v9, v66, 0xc0135761
    v_fmaak_f32 v67, v9, v67, 0xc0135761
    v_fmaak_f32 v68, v9, v68, 0xc0135761
    v_fmaak_f32 v69, v9, v69, 0xc0135761
    v_fmaak_f32 v70, v9, v70, 0xc0135761
    v_fmaak_f32 v71, v9, v71, 0xc0135761
    v_mul_f32 v64, v64, v202
    ds_read_b128 v[48:51], v177
    v_mul_f32 v65, v65, v203
    v_mul_f32 v66, v66, v204
    v_mul_f32 v67, v67, v205
    v_mul_f32 v68, v68, v206
    v_mul_f32 v69, v69, v207
    v_mul_f32 v70, v70, v208
    v_mul_f32 v71, v71, v209
    v_exp_f32 v64, v64
    ds_read_b128 v[52:55], v178
    v_exp_f32 v65, v65
    v_exp_f32 v66, v66
    v_exp_f32 v67, v67
    v_exp_f32 v68, v68
    v_exp_f32 v69, v69
    v_exp_f32 v70, v70
    v_exp_f32 v71, v71
    v_fma_f32 v64, v64, s81, s81
    ds_read_b128 v[56:59], v179
    v_fma_f32 v65, v65, s81, s81
    v_fma_f32 v66, v66, s81, s81
    v_fma_f32 v67, v67, s81, s81
    v_fma_f32 v68, v68, s81, s81
    v_fma_f32 v69, v69, s81, s81
    v_fma_f32 v70, v70, s81, s81
    v_fma_f32 v71, v71, s81, s81
    v_rcp_f32 v64, v64
    ds_read_b128 v[60:63], v180
    v_rcp_f32 v65, v65
    v_rcp_f32 v66, v66
    v_rcp_f32 v67, v67
    v_rcp_f32 v68, v68
    v_rcp_f32 v69, v69
    v_rcp_f32 v70, v70
    v_rcp_f32 v71, v71
    v_mul_f32 v202, v202, v64
    v_mul_f32 v203, v203, v65
    v_mul_f32 v204, v204, v66
    v_mul_f32 v205, v205, v67
    v_mul_f32 v206, v206, v68
    v_mul_f32 v207, v207, v69
    v_mul_f32 v208, v208, v70
    v_mul_f32 v209, v209, v71
    s_mov_b64 exec, 1
    ds_add_u32 v251, v252 offset:12
    s_mov_b64 exec, -1
    v_cvt_pk_bf16_f32 v180, v202, v203
    v_cvt_pk_bf16_f32 v181, v204, v205
    v_cvt_pk_bf16_f32 v182, v206, v207
    v_cvt_pk_bf16_f32 v183, v208, v209
    s_nop 1
    v_mfma_f32_32x32x16_bf16 v[218:233], v[186:189], v[180:183], 0
    v_mov_b32 v123, 0
    v_mov_b32 v131, 0
    v_mov_b32 v139, 0
    v_mov_b32 v147, 0
    v_mov_b32 v155, 0
    v_mov_b32 v163, 0
    v_mov_b32 v171, 0
    v_mov_b32 v179, 0
    s_nop 3
    v_exp_f32 v180, v218
    v_exp_f32 v181, v219
    v_exp_f32 v182, v220
    v_exp_f32 v183, v221
    v_exp_f32 v184, v222
    v_exp_f32 v185, v223
    v_exp_f32 v186, v224
    v_exp_f32 v187, v225
    v_exp_f32 v188, v226
    v_exp_f32 v189, v227
    v_exp_f32 v190, v228
    v_exp_f32 v191, v229
    v_exp_f32 v192, v230
    v_add_f32 v180, 1.0, v180
    v_add_f32 v181, 1.0, v181
    v_add_f32 v182, 1.0, v182
    v_add_f32 v183, 1.0, v183
    v_add_f32 v184, 1.0, v184
    v_add_f32 v185, 1.0, v185
    v_add_f32 v186, 1.0, v186
    v_add_f32 v187, 1.0, v187
    v_add_f32 v188, 1.0, v188
    v_add_f32 v189, 1.0, v189
    v_add_f32 v190, 1.0, v190
    v_add_f32 v191, 1.0, v191
    v_add_f32 v192, 1.0, v192
    v_rcp_f32 v180, v180
    v_rcp_f32 v181, v181
    v_rcp_f32 v182, v182
    v_rcp_f32 v183, v183
    v_rcp_f32 v184, v184
    v_rcp_f32 v185, v185
    v_rcp_f32 v186, v186
    v_rcp_f32 v187, v187
    v_rcp_f32 v188, v188
    v_rcp_f32 v189, v189
    v_rcp_f32 v190, v190
    v_rcp_f32 v191, v191
    v_rcp_f32 v192, v192
    s_cmp_eq_u32 s48, 4
    s_cbranch_scc0 L_rdi
    buffer_load_dword v253, v254, s[40:43], 0 offen sc1
L_rdi:
    v_cvt_pk_bf16_f32 v180, v180, 0
    v_cvt_pk_bf16_f32 v181, v181, 0
    v_cvt_pk_bf16_f32 v182, v182, 0
    v_cvt_pk_bf16_f32 v183, v183, 0
    v_cvt_pk_bf16_f32 v184, v184, 0
    v_cvt_pk_bf16_f32 v185, v185, 0
    v_cvt_pk_bf16_f32 v186, v186, 0
    v_cvt_pk_bf16_f32 v187, v187, 0
    v_cvt_pk_bf16_f32 v188, v188, 0
    v_cvt_pk_bf16_f32 v189, v189, 0
    v_cvt_pk_bf16_f32 v190, v190, 0
    v_cvt_pk_bf16_f32 v191, v191, 0
    v_cvt_pk_bf16_f32 v192, v192, 0
    s_waitcnt lgkmcnt(13)
    v_dot2_f32_bf16 v202, v12, v180, 0
    s_waitcnt lgkmcnt(12)
    v_dot2_f32_bf16 v203, v16, v181, 0
    s_waitcnt lgkmcnt(11)
    v_dot2_f32_bf16 v204, v20, v182, 0
    s_waitcnt lgkmcnt(10)
    v_dot2_f32_bf16 v205, v24, v183, 0
    s_waitcnt lgkmcnt(9)
    v_dot2_f32_bf16 v206, v28, v184, 0
    s_waitcnt lgkmcnt(8)
    v_dot2_f32_bf16 v207, v32, v185, 0
    s_waitcnt lgkmcnt(7)
    v_dot2_f32_bf16 v208, v36, v186, 0
    s_waitcnt lgkmcnt(6)
    v_dot2_f32_bf16 v209, v40, v187, 0
    s_waitcnt lgkmcnt(5)
    v_dot2_f32_bf16 v210, v44, v188, 0
    s_waitcnt lgkmcnt(4)
    v_dot2_f32_bf16 v211, v48, v189, 0
    s_waitcnt lgkmcnt(3)
    v_dot2_f32_bf16 v212, v52, v190, 0
    s_waitcnt lgkmcnt(2)
    v_dot2_f32_bf16 v213, v56, v191, 0
    s_waitcnt lgkmcnt(1)
    v_dot2_f32_bf16 v214, v60, v192, 0
    v_cvt_pk_bf16_f32 v116, v202, v203
    v_cvt_pk_bf16_f32 v117, v204, v205
    v_cvt_pk_bf16_f32 v118, v206, v207
    v_cvt_pk_bf16_f32 v119, v208, v209
    v_cvt_pk_bf16_f32 v120, v210, v211
    v_cvt_pk_bf16_f32 v121, v212, v213
    v_cvt_pk_bf16_f32 v122, v214, 0
    v_dot2_f32_bf16 v202, v13, v180, 0
    v_dot2_f32_bf16 v203, v17, v181, 0
    v_dot2_f32_bf16 v204, v21, v182, 0
    v_dot2_f32_bf16 v205, v25, v183, 0
    v_dot2_f32_bf16 v206, v29, v184, 0
    v_dot2_f32_bf16 v207, v33, v185, 0
    v_dot2_f32_bf16 v208, v37, v186, 0
    v_dot2_f32_bf16 v209, v41, v187, 0
    v_dot2_f32_bf16 v210, v45, v188, 0
    v_dot2_f32_bf16 v211, v49, v189, 0
    v_dot2_f32_bf16 v212, v53, v190, 0
    v_dot2_f32_bf16 v213, v57, v191, 0
    v_dot2_f32_bf16 v214, v61, v192, 0
    v_cvt_pk_bf16_f32 v132, v202, v203
    v_cvt_pk_bf16_f32 v133, v204, v205
    v_cvt_pk_bf16_f32 v134, v206, v207
    v_cvt_pk_bf16_f32 v135, v208, v209
    v_cvt_pk_bf16_f32 v136, v210, v211
    v_cvt_pk_bf16_f32 v137, v212, v213
    v_cvt_pk_bf16_f32 v138, v214, 0
    v_dot2_f32_bf16 v202, v14, v180, 0
    v_dot2_f32_bf16 v203, v18, v181, 0
    v_dot2_f32_bf16 v204, v22, v182, 0
    v_dot2_f32_bf16 v205, v26, v183, 0
    v_dot2_f32_bf16 v206, v30, v184, 0
    v_dot2_f32_bf16 v207, v34, v185, 0
    v_dot2_f32_bf16 v208, v38, v186, 0
    v_dot2_f32_bf16 v209, v42, v187, 0
    v_dot2_f32_bf16 v210, v46, v188, 0
    v_dot2_f32_bf16 v211, v50, v189, 0
    v_dot2_f32_bf16 v212, v54, v190, 0
    v_dot2_f32_bf16 v213, v58, v191, 0
    v_dot2_f32_bf16 v214, v62, v192, 0
    v_cvt_pk_bf16_f32 v148, v202, v203
    v_cvt_pk_bf16_f32 v149, v204, v205
    v_cvt_pk_bf16_f32 v150, v206, v207
    v_cvt_pk_bf16_f32 v151, v208, v209
    v_cvt_pk_bf16_f32 v152, v210, v211
    v_cvt_pk_bf16_f32 v153, v212, v213
    v_cvt_pk_bf16_f32 v154, v214, 0
    v_dot2_f32_bf16 v202, v15, v180, 0
    v_dot2_f32_bf16 v203, v19, v181, 0
    v_dot2_f32_bf16 v204, v23, v182, 0
    v_dot2_f32_bf16 v205, v27, v183, 0
    v_dot2_f32_bf16 v206, v31, v184, 0
    v_dot2_f32_bf16 v207, v35, v185, 0
    v_dot2_f32_bf16 v208, v39, v186, 0
    v_dot2_f32_bf16 v209, v43, v187, 0
    v_dot2_f32_bf16 v210, v47, v188, 0
    v_dot2_f32_bf16 v211, v51, v189, 0
    v_dot2_f32_bf16 v212, v55, v190, 0
    v_dot2_f32_bf16 v213, v59, v191, 0
    v_dot2_f32_bf16 v214, v63, v192, 0
    v_cvt_pk_bf16_f32 v164, v202, v203
    v_cvt_pk_bf16_f32 v165, v204, v205
    v_cvt_pk_bf16_f32 v166, v206, v207
    v_cvt_pk_bf16_f32 v167, v208, v209
    v_cvt_pk_bf16_f32 v168, v210, v211
    v_cvt_pk_bf16_f32 v169, v212, v213
    v_cvt_pk_bf16_f32 v170, v214, 0
    v_lshlrev_b32 v180, 16, v180
    v_lshlrev_b32 v181, 16, v181
    v_lshlrev_b32 v182, 16, v182
    v_lshlrev_b32 v183, 16, v183
    v_lshlrev_b32 v184, 16, v184
    v_lshlrev_b32 v185, 16, v185
    v_lshlrev_b32 v186, 16, v186
    v_lshlrev_b32 v187, 16, v187
    v_lshlrev_b32 v188, 16, v188
    v_lshlrev_b32 v189, 16, v189
    v_lshlrev_b32 v190, 16, v190
    v_lshlrev_b32 v191, 16, v191
    v_lshlrev_b32 v192, 16, v192
    v_dot2_f32_bf16 v202, v12, v180, 0
    v_dot2_f32_bf16 v203, v16, v181, 0
    v_dot2_f32_bf16 v204, v20, v182, 0
    v_dot2_f32_bf16 v205, v24, v183, 0
    v_dot2_f32_bf16 v206, v28, v184, 0
    v_dot2_f32_bf16 v207, v32, v185, 0
    v_dot2_f32_bf16 v208, v36, v186, 0
    v_dot2_f32_bf16 v209, v40, v187, 0
    v_dot2_f32_bf16 v210, v44, v188, 0
    v_dot2_f32_bf16 v211, v48, v189, 0
    v_dot2_f32_bf16 v212, v52, v190, 0
    v_dot2_f32_bf16 v213, v56, v191, 0
    v_dot2_f32_bf16 v214, v60, v192, 0
    v_cvt_pk_bf16_f32 v124, v202, v203
    v_cvt_pk_bf16_f32 v125, v204, v205
    v_cvt_pk_bf16_f32 v126, v206, v207
    v_cvt_pk_bf16_f32 v127, v208, v209
    v_cvt_pk_bf16_f32 v128, v210, v211
    v_cvt_pk_bf16_f32 v129, v212, v213
    v_cvt_pk_bf16_f32 v130, v214, 0
    v_dot2_f32_bf16 v202, v13, v180, 0
    v_dot2_f32_bf16 v203, v17, v181, 0
    v_dot2_f32_bf16 v204, v21, v182, 0
    v_dot2_f32_bf16 v205, v25, v183, 0
    v_dot2_f32_bf16 v206, v29, v184, 0
    v_dot2_f32_bf16 v207, v33, v185, 0
    v_dot2_f32_bf16 v208, v37, v186, 0
    v_dot2_f32_bf16 v209, v41, v187, 0
    v_dot2_f32_bf16 v210, v45, v188, 0
    v_dot2_f32_bf16 v211, v49, v189, 0
    v_dot2_f32_bf16 v212, v53, v190, 0
    v_dot2_f32_bf16 v213, v57, v191, 0
    v_dot2_f32_bf16 v214, v61, v192, 0
    v_cvt_pk_bf16_f32 v140, v202, v203
    v_cvt_pk_bf16_f32 v141, v204, v205
    v_cvt_pk_bf16_f32 v142, v206, v207
    v_cvt_pk_bf16_f32 v143, v208, v209
    v_cvt_pk_bf16_f32 v144, v210, v211
    v_cvt_pk_bf16_f32 v145, v212, v213
    v_cvt_pk_bf16_f32 v146, v214, 0
    s_cmp_eq_u32 s48, 4
    s_cbranch_scc0 L_rs1w
    s_cmp_lg_u32 s84, 0
    s_cbranch_scc1 L_rs1e
    s_waitcnt vmcnt(0)
    v_readfirstlane_b32 s100, v253
    s_nop 0
    s_and_b32 s101, s100, 0xff
    s_cmp_ge_u32 s101, 8
    s_cbranch_scc1 L_rs1k
    buffer_load_dword v253, v254, s[40:43], 0 offen sc1
    s_branch L_rs1e
L_rs1k:
    s_cmp_eq_u32 s100, s83
    s_cselect_b32 s84, 2, 1
    v_mov_b32 v5, s84
    ds_write_b32 v251, v5 offset:20
L_rs1e:
L_rs1w:
    ds_read_b32 v6, v251 offset:0
    s_waitcnt lgkmcnt(0)
    v_readfirstlane_b32 s100, v6
    s_nop 0
    s_cmp_ge_u32 s100, 4
    s_cbranch_scc1 L_sw7x
L_sw7:
    s_sleep 1
    ds_read_b32 v6, v251 offset:0
    s_waitcnt lgkmcnt(0)
    v_readfirstlane_b32 s100, v6
    s_add_u32 s59, s59, 1
    s_cmp_ge_u32 s59, 0x1000000
    s_cbranch_scc1 L_sw7x
    s_cmp_ge_u32 s100, 4
    s_cbranch_scc0 L_sw7
L_sw7x:
    ds_read_b128 v[64:67], v3 offset:0
    ds_read_b128 v[68:71], v3 offset:16
    ds_read_b128 v[72:75], v3 offset:32
    ds_read_b128 v[76:79], v3 offset:48
    ds_read_b128 v[80:83], v3 offset:64
    ds_read_b128 v[84:87], v3 offset:80
    ds_read_b128 v[88:91], v3 offset:96
    ds_read_b128 v[92:95], v3 offset:112
    ds_read_b128 v[96:99], v3 offset:128
    ds_read_b128 v[100:103], v3 offset:144
    ds_read_b128 v[104:107], v3 offset:160
    ds_read_b128 v[108:111], v3 offset:176
    ds_read_b128 v[112:115], v3 offset:192
    s_mov_b64 exec, 1
    ds_add_u32 v251, v252 offset:4
    s_mov_b64 exec, -1
    v_dot2_f32_bf16 v202, v14, v180, 0
    v_dot2_f32_bf16 v203, v18, v181, 0
    v_dot2_f32_bf16 v204, v22, v182, 0
    v_dot2_f32_bf16 v205, v26, v183, 0
    v_dot2_f32_bf16 v206, v30, v184, 0
    v_dot2_f32_bf16 v207, v34, v185, 0
    v_dot2_f32_bf16 v208, v38, v186, 0
    v_dot2_f32_bf16 v209, v42, v187, 0
    v_dot2_f32_bf16 v210, v46, v188, 0
    v_dot2_f32_bf16 v211, v50, v189, 0
    v_dot2_f32_bf16 v212, v54, v190, 0
    v_dot2_f32_bf16 v213, v58, v191, 0
    v_dot2_f32_bf16 v214, v62, v192, 0
    v_cvt_pk_bf16_f32 v156, v202, v203
    v_cvt_pk_bf16_f32 v157, v204, v205
    v_cvt_pk_bf16_f32 v158, v206, v207
    v_cvt_pk_bf16_f32 v159, v208, v209
    v_cvt_pk_bf16_f32 v160, v210, v211
    v_cvt_pk_bf16_f32 v161, v212, v213
    v_cvt_pk_bf16_f32 v162, v214, 0
    v_dot2_f32_bf16 v202, v15, v180, 0
    v_dot2_f32_bf16 v203, v19, v181, 0
    v_dot2_f32_bf16 v204, v23, v182, 0
    v_dot2_f32_bf16 v205, v27, v183, 0
    v_dot2_f32_bf16 v206, v31, v184, 0
    v_dot2_f32_bf16 v207, v35, v185, 0
    v_dot2_f32_bf16 v208, v39, v186, 0
    v_dot2_f32_bf16 v209, v43, v187, 0
    v_dot2_f32_bf16 v210, v47, v188, 0
    v_dot2_f32_bf16 v211, v51, v189, 0
    v_dot2_f32_bf16 v212, v55, v190, 0
    v_dot2_f32_bf16 v213, v59, v191, 0
    v_dot2_f32_bf16 v214, v63, v192, 0
    v_cvt_pk_bf16_f32 v172, v202, v203
    v_cvt_pk_bf16_f32 v173, v204, v205
    v_cvt_pk_bf16_f32 v174, v206, v207
    v_cvt_pk_bf16_f32 v175, v208, v209
    v_cvt_pk_bf16_f32 v176, v210, v211
    v_cvt_pk_bf16_f32 v177, v212, v213
    v_cvt_pk_bf16_f32 v178, v214, 0
    s_cmp_eq_u32 s48, 4
    s_cbranch_scc0 L_rs2w
    s_cmp_lg_u32 s84, 0
    s_cbranch_scc1 L_rs2e
    s_waitcnt vmcnt(0)
    v_readfirstlane_b32 s100, v253
    s_nop 0
    s_and_b32 s101, s100, 0xff
    s_cmp_ge_u32 s101, 8
    s_cbranch_scc1 L_rs2k
    buffer_load_dword v253, v254, s[40:43], 0 offen sc1
    s_branch L_rs2e
L_rs2k:
    s_cmp_eq_u32 s100, s83
    s_cselect_b32 s84, 2, 1
    v_mov_b32 v5, s84
    ds_write_b32 v251, v5 offset:20
L_rs2e:
L_rs2w:
    s_setprio 1
    v_mov_b32 v201, 0
    s_waitcnt lgkmcnt(12)
    v_perm_b32 v194, v68, v64, s60
    s_waitcnt lgkmcnt(10)
    v_perm_b32 v195, v76, v72, s60
    s_waitcnt lgkmcnt(8)
    v_perm_b32 v196, v84, v80, s60
    s_waitcnt lgkmcnt(6)
    v_perm_b32 v197, v92, v88, s60
    s_waitcnt lgkmcnt(4)
    v_perm_b32 v198, v100, v96, s60
    s_waitcnt lgkmcnt(2)
    v_perm_b32 v199, v108, v104, s60
    s_waitcnt lgkmcnt(1)
    v_perm_b32 v200, v112, v112, s73
    v_mfma_f32_32x32x16_bf16 v[202:217], v[194:197], v[116:119], 0
    s_nop 0
    v_mfma_f32_32x32x16_bf16 v[202:217], v[198:201], v[120:123], v[202:217]
    v_perm_b32 v194, v68, v64, s61
    v_perm_b32 v195, v76, v72, s61
    v_perm_b32 v196, v84, v80, s61
    v_perm_b32 v197, v92, v88, s61
    v_perm_b32 v198, v100, v96, s61
    v_perm_b32 v199, v108, v104, s61
    v_perm_b32 v200, v112, v112, s74
    ds_read_b128 v[116:119], v234
    ds_read_b128 v[120:123], v235
    v_mfma_f32_32x32x16_bf16 v[218:233], v[194:197], v[124:127], 0
    v_mfma_f32_32x32x16_bf16 v[218:233], v[198:201], v[128:131], v[218:233]
    ds_read_b128 v[124:127], v236
    ds_read_b128 v[128:131], v237
    v_perm_b32 v194, v69, v65, s60
    v_perm_b32 v195, v77, v73, s60
    v_perm_b32 v196, v85, v81, s60
    v_perm_b32 v197, v93, v89, s60
    v_perm_b32 v198, v101, v97, s60
    v_perm_b32 v199, v109, v105, s60
    v_perm_b32 v200, v113, v113, s73
    s_nop 2
    v_cvt_pk_bf16_f32 v64, v202, v218
    v_cvt_pk_bf16_f32 v68, v203, v219
    v_cvt_pk_bf16_f32 v72, v204, v220
    v_cvt_pk_bf16_f32 v76, v205, v221
    v_cvt_pk_bf16_f32 v80, v206, v222
    v_cvt_pk_bf16_f32 v84, v207, v223
    v_cvt_pk_bf16_f32 v88, v208, v224
    v_cvt_pk_bf16_f32 v92, v209, v225
    v_cvt_pk_bf16_f32 v96, v210, v226
    v_cvt_pk_bf16_f32 v100, v211, v227
    v_cvt_pk_bf16_f32 v104, v212, v228
    v_cvt_pk_bf16_f32 v108, v213, v229
    v_cvt_pk_bf16_f32 v112, v214, v230
    v_mfma_f32_32x32x16_bf16 v[202:217], v[194:197], v[132:135], 0
    v_mfma_f32_32x32x16_bf16 v[202:217], v[198:201], v[136:139], v[202:217]
    v_perm_b32 v194, v69, v65, s61
    v_perm_b32 v195, v77, v73, s61
    v_perm_b32 v196, v85, v81, s61
    v_perm_b32 v197, v93, v89, s61
    v_perm_b32 v198, v101, v97, s61
    v_perm_b32 v199, v109, v105, s61
    v_perm_b32 v200, v113, v113, s74
    ds_read_b128 v[132:135], v238
    ds_read_b128 v[136:139], v239
    v_mfma_f32_32x32x16_bf16 v[218:233], v[194:197], v[140:143], 0
    v_mfma_f32_32x32x16_bf16 v[218:233], v[198:201], v[144:147], v[218:233]
    ds_read_b128 v[140:143], v240
    ds_read_b128 v[144:147], v241
    v_perm_b32 v194, v70, v66, s60
    v_perm_b32 v195, v78, v74, s60
    v_perm_b32 v196, v86, v82, s60
    v_perm_b32 v197, v94, v90, s60
    v_perm_b32 v198, v102, v98, s60
    v_perm_b32 v199, v110, v106, s60
    v_perm_b32 v200, v114, v114, s73
    s_nop 2
    v_cvt_pk_bf16_f32 v65, v202, v218
    v_cvt_pk_bf16_f32 v69, v203, v219
    v_cvt_pk_bf16_f32 v73, v204, v220
    v_cvt_pk_bf16_f32 v77, v205, v221
    v_cvt_pk_bf16_f32 v81, v206, v222
    v_cvt_pk_bf16_f32 v85, v207, v223
    v_cvt_pk_bf16_f32 v89, v208, v224
    v_cvt_pk_bf16_f32 v93, v209, v225
    v_cvt_pk_bf16_f32 v97, v210, v226
    v_cvt_pk_bf16_f32 v101, v211, v227
    v_cvt_pk_bf16_f32 v105, v212, v228
    v_cvt_pk_bf16_f32 v109, v213, v229
    v_cvt_pk_bf16_f32 v113, v214, v230
    v_mfma_f32_32x32x16_bf16 v[202:217], v[194:197], v[148:151], 0
    v_mfma_f32_32x32x16_bf16 v[202:217], v[198:201], v[152:155], v[202:217]
    v_perm_b32 v194, v70, v66, s61
    v_perm_b32 v195, v78, v74, s61
    v_perm_b32 v196, v86, v82, s61
    v_perm_b32 v197, v94, v90, s61
    v_perm_b32 v198, v102, v98, s61
    v_perm_b32 v199, v110, v106, s61
    v_perm_b32 v200, v114, v114, s74
    ds_read_b128 v[148:151], v242
    ds_read_b128 v[152:155], v243
    v_mfma_f32_32x32x16_bf16 v[218:233], v[194:197], v[156:159], 0
    v_mfma_f32_32x32x16_bf16 v[218:233], v[198:201], v[160:163], v[218:233]
    ds_read_b128 v[156:159], v244
    ds_read_b128 v[160:163], v245
    v_perm_b32 v194, v71, v67, s60
    v_perm_b32 v195, v79, v75, s60
    v_perm_b32 v196, v87, v83, s60
    v_perm_b32 v197, v95, v91, s60
    v_perm_b32 v198, v103, v99, s60
    v_perm_b32 v199, v111, v107, s60
    v_perm_b32 v200, v115, v115, s73
    s_nop 2
    v_cvt_pk_bf16_f32 v66, v202, v218
    v_cvt_pk_bf16_f32 v70, v203, v219
    v_cvt_pk_bf16_f32 v74, v204, v220
    v_cvt_pk_bf16_f32 v78, v205, v221
    v_cvt_pk_bf16_f32 v82, v206, v222
    v_cvt_pk_bf16_f32 v86, v207, v223
    v_cvt_pk_bf16_f32 v90, v208, v224
    v_cvt_pk_bf16_f32 v94, v209, v225
    v_cvt_pk_bf16_f32 v98, v210, v226
    v_cvt_pk_bf16_f32 v102, v211, v227
    v_cvt_pk_bf16_f32 v106, v212, v228
    v_cvt_pk_bf16_f32 v110, v213, v229
    v_cvt_pk_bf16_f32 v114, v214, v230
    v_mfma_f32_32x32x16_bf16 v[202:217], v[194:197], v[164:167], 0
    v_mfma_f32_32x32x16_bf16 v[202:217], v[198:201], v[168:171], v[202:217]
    v_perm_b32 v194, v71, v67, s61
    v_perm_b32 v195, v79, v75, s61
    v_perm_b32 v196, v87, v83, s61
    v_perm_b32 v197, v95, v91, s61
    v_perm_b32 v198, v103, v99, s61
    v_perm_b32 v199, v111, v107, s61
    v_perm_b32 v200, v115, v115, s74
    ds_read_b128 v[164:167], v246
    v_mfma_f32_32x32x16_bf16 v[218:233], v[194:197], v[172:175], 0
    v_mfma_f32_32x32x16_bf16 v[218:233], v[198:201], v[176:179], v[218:233]
    s_cmp_eq_u32 s48, 4
    s_cbranch_scc0 L_rhw
    s_cmp_lg_u32 s84, 0
    s_cbranch_scc1 L_rhe
    s_branch L_chkr
L_chk:
    buffer_load_dword v253, v254, s[40:43], 0 offen sc1
L_chkr:
    s_waitcnt vmcnt(0)
    v_readfirstlane_b32 s100, v253
    s_add_u32 s59, s59, 64
    s_cmp_ge_u32 s59, 0x1000000
    s_cbranch_scc1 L_chkx
    s_and_b32 s101, s100, 0xff
    s_cmp_ge_u32 s101, 8
    s_cbranch_scc1 L_chkx
    s_sleep 16
    s_branch L_chk
L_chkx:
    s_cmp_eq_u32 s100, s83
    s_cselect_b32 s100, 2, 1
    v_mov_b32 v5, s100
    ds_write_b32 v251, v5 offset:20
    s_waitcnt lgkmcnt(0)
L_rhe:
L_rhw:
    ds_read_b32 v6, v251 offset:8
    s_waitcnt lgkmcnt(0)
    v_readfirstlane_b32 s100, v6
    s_nop 0
    s_cmp_ge_u32 s100, 4
    s_cbranch_scc1 L_sw8x
L_sw8:
    s_sleep 1
    ds_read_b32 v6, v251 offset:8
    s_waitcnt lgkmcnt(0)
    v_readfirstlane_b32 s100, v6
    s_add_u32 s59, s59, 1
    s_cmp_ge_u32 s59, 0x1000000
    s_cbranch_scc1 L_sw8x
    s_cmp_ge_u32 s100, 4
    s_cbranch_scc0 L_sw8
L_sw8x:
    v_cvt_pk_bf16_f32 v67, v202, v218
    v_cvt_pk_bf16_f32 v71, v203, v219
    v_cvt_pk_bf16_f32 v75, v204, v220
    v_cvt_pk_bf16_f32 v79, v205, v221
    v_cvt_pk_bf16_f32 v83, v206, v222
    v_cvt_pk_bf16_f32 v87, v207, v223
    v_cvt_pk_bf16_f32 v91, v208, v224
    v_cvt_pk_bf16_f32 v95, v209, v225
    v_cvt_pk_bf16_f32 v99, v210, v226
    v_cvt_pk_bf16_f32 v103, v211, v227
    v_cvt_pk_bf16_f32 v107, v212, v228
    v_cvt_pk_bf16_f32 v111, v213, v229
    v_cvt_pk_bf16_f32 v115, v214, v230
    v_dot2_f32_bf16 v234, v116, v64, 0
    v_dot2_f32_bf16 v235, v120, v68, 0
    v_dot2_f32_bf16 v236, v124, v72, 0
    v_dot2_f32_bf16 v237, v128, v76, 0
    v_dot2_f32_bf16 v234, v117, v65, v234
    v_dot2_f32_bf16 v235, v121, v69, v235
    v_dot2_f32_bf16 v236, v125, v73, v236
    v_dot2_f32_bf16 v237, v129, v77, v237
    v_dot2_f32_bf16 v234, v118, v66, v234
    v_dot2_f32_bf16 v235, v122, v70, v235
    v_dot2_f32_bf16 v236, v126, v74, v236
    v_dot2_f32_bf16 v237, v130, v78, v237
    v_dot2_f32_bf16 v234, v119, v67, v234
    v_dot2_f32_bf16 v235, v123, v71, v235
    v_dot2_f32_bf16 v236, v127, v75, v236
    v_dot2_f32_bf16 v237, v131, v79, v237
    ds_read_b128 v[64:67], v4 offset:0
    ds_read_b128 v[68:71], v4 offset:16
    ds_read_b128 v[72:75], v4 offset:32
    ds_read_b128 v[76:79], v4 offset:48
    v_dot2_f32_bf16 v238, v132, v80, 0
    v_dot2_f32_bf16 v239, v136, v84, 0
    v_dot2_f32_bf16 v240, v140, v88, 0
    v_dot2_f32_bf16 v241, v144, v92, 0
    v_dot2_f32_bf16 v238, v133, v81, v238
    v_dot2_f32_bf16 v239, v137, v85, v239
    v_dot2_f32_bf16 v240, v141, v89, v240
    v_dot2_f32_bf16 v241, v145, v93, v241
    v_dot2_f32_bf16 v238, v134, v82, v238
    v_dot2_f32_bf16 v239, v138, v86, v239
    v_dot2_f32_bf16 v240, v142, v90, v240
    v_dot2_f32_bf16 v241, v146, v94, v241
    v_dot2_f32_bf16 v238, v135, v83, v238
    v_dot2_f32_bf16 v239, v139, v87, v239
    v_dot2_f32_bf16 v240, v143, v91, v240
    v_dot2_f32_bf16 v241, v147, v95, v241
    ds_read_b128 v[80:83], v4 offset:64
    ds_read_b128 v[84:87], v4 offset:80
    ds_read_b128 v[88:91], v4 offset:96
    ds_read_b128 v[92:95], v4 offset:112
    v_dot2_f32_bf16 v242, v148, v96, 0
    v_dot2_f32_bf16 v243, v152, v100, 0
    v_dot2_f32_bf16 v244, v156, v104, 0
    v_dot2_f32_bf16 v245, v160, v108, 0
    v_dot2_f32_bf16 v242, v149, v97, v242
    v_dot2_f32_bf16 v243, v153, v101, v243
    v_dot2_f32_bf16 v244, v157, v105, v244
    v_dot2_f32_bf16 v245, v161, v109, v245
    v_dot2_f32_bf16 v242, v150, v98, v242
    v_dot2_f32_bf16 v243, v154, v102, v243
    v_dot2_f32_bf16 v244, v158, v106, v244
    v_dot2_f32_bf16 v245, v162, v110, v245
    v_dot2_f32_bf16 v242, v151, v99, v242
    v_dot2_f32_bf16 v243, v155, v103, v243
    v_dot2_f32_bf16 v244, v159, v107, v244
    v_dot2_f32_bf16 v245, v163, v111, v245
    ds_read_b128 v[96:99], v4 offset:128
    ds_read_b128 v[100:103], v4 offset:144
    ds_read_b128 v[104:107], v4 offset:160
    ds_read_b128 v[108:111], v4 offset:176
    v_dot2_f32_bf16 v246, v164, v112, 0
    v_dot2_f32_bf16 v246, v165, v113, v246
    v_dot2_f32_bf16 v246, v166, v114, v246
    v_dot2_f32_bf16 v246, v167, v115, v246
    ds_read_b128 v[112:115], v4 offset:192
    v_mul_f32 v247, v234, v180
    v_mul_f32 v248, v235, v181
    v_fmac_f32 v247, v236, v182
    v_fmac_f32 v248, v237, v183
    v_fmac_f32 v247, v238, v184
    v_fmac_f32 v248, v239, v185
    v_fmac_f32 v247, v240, v186
    v_fmac_f32 v248, v241, v187
    v_fmac_f32 v247, v242, v188
    v_fmac_f32 v248, v243, v189
    v_fmac_f32 v247, v244, v190
    v_fmac_f32 v248, v245, v191
    v_fmac_f32 v247, v246, v192
    v_mov_b32 v187, 0
    v_perm_b32 v180, v16, v12, s60
    v_perm_b32 v181, v24, v20, s60
    v_perm_b32 v182, v32, v28, s60
    v_perm_b32 v183, v40, v36, s60
    v_perm_b32 v184, v48, v44, s60
    v_perm_b32 v185, v56, v52, s60
    v_perm_b32 v186, v60, v60, s73
    s_waitcnt lgkmcnt(11)
    v_perm_b32 v194, v68, v64, s60
    s_waitcnt lgkmcnt(9)
    v_perm_b32 v195, v76, v72, s60
    s_waitcnt lgkmcnt(7)
    v_perm_b32 v196, v84, v80, s60
    s_waitcnt lgkmcnt(5)
    v_perm_b32 v197, v92, v88, s60
    s_waitcnt lgkmcnt(3)
    v_perm_b32 v198, v100, v96, s60
    s_waitcnt lgkmcnt(1)
    v_perm_b32 v199, v108, v104, s60
    s_waitcnt lgkmcnt(0)
    v_perm_b32 v200, v112, v112, s73
    v_mfma_f32_32x32x16_bf16 v[202:217], v[194:197], v[180:183], 0
    s_nop 0
    v_mfma_f32_32x32x16_bf16 v[202:217], v[198:201], v[184:187], v[202:217]
    v_perm_b32 v194, v68, v64, s61
    v_perm_b32 v195, v76, v72, s61
    v_perm_b32 v196, v84, v80, s61
    v_perm_b32 v197, v92, v88, s61
    v_perm_b32 v198, v100, v96, s61
    v_perm_b32 v199, v108, v104, s61
    v_perm_b32 v200, v112, v112, s74
    v_perm_b32 v180, v16, v12, s61
    v_perm_b32 v181, v24, v20, s61
    v_perm_b32 v182, v32, v28, s61
    v_perm_b32 v183, v40, v36, s61
    v_perm_b32 v184, v48, v44, s61
    v_perm_b32 v185, v56, v52, s61
    v_perm_b32 v186, v60, v60, s74
    v_mfma_f32_32x32x16_bf16 v[218:233], v[194:197], v[180:183], 0
    s_nop 0
    v_mfma_f32_32x32x16_bf16 v[218:233], v[198:201], v[184:187], v[218:233]
    v_perm_b32 v194, v69, v65, s60
    v_perm_b32 v195, v77, v73, s60
    v_perm_b32 v196, v85, v81, s60
    v_perm_b32 v197, v93, v89, s60
    v_perm_b32 v198, v101, v97, s60
    v_perm_b32 v199, v109, v105, s60
    v_perm_b32 v200, v113, v113, s73
    v_perm_b32 v180, v17, v13, s60
    v_perm_b32 v181, v25, v21, s60
    v_perm_b32 v182, v33, v29, s60
    v_perm_b32 v183, v41, v37, s60
    v_perm_b32 v184, v49, v45, s60
    v_perm_b32 v185, v57, v53, s60
    v_perm_b32 v186, v61, v61, s73
    v_cvt_pk_bf16_f32 v64, v202, v218
    v_cvt_pk_bf16_f32 v68, v203, v219
    v_cvt_pk_bf16_f32 v72, v204, v220
    v_cvt_pk_bf16_f32 v76, v205, v221
    v_cvt_pk_bf16_f32 v80, v206, v222
    v_cvt_pk_bf16_f32 v84, v207, v223
    v_cvt_pk_bf16_f32 v88, v208, v224
    v_cvt_pk_bf16_f32 v92, v209, v225
    v_cvt_pk_bf16_f32 v96, v210, v226
    v_cvt_pk_bf16_f32 v100, v211, v227
    v_cvt_pk_bf16_f32 v104, v212, v228
    v_cvt_pk_bf16_f32 v108, v213, v229
    v_cvt_pk_bf16_f32 v112, v214, v230
    v_dot2_f32_bf16 v234, v116, v64, 0
    v_dot2_f32_bf16 v235, v120, v68, 0
    v_dot2_f32_bf16 v236, v124, v72, 0
    v_dot2_f32_bf16 v237, v128, v76, 0
    v_dot2_f32_bf16 v234, v132, v80, v234
    v_dot2_f32_bf16 v235, v136, v84, v235
    v_dot2_f32_bf16 v236, v140, v88, v236
    v_dot2_f32_bf16 v237, v144, v92, v237
    v_dot2_f32_bf16 v234, v148, v96, v234
    v_dot2_f32_bf16 v235, v152, v100, v235
    v_dot2_f32_bf16 v236, v156, v104, v236
    v_dot2_f32_bf16 v237, v160, v108, v237
    v_dot2_f32_bf16 v234, v164, v112, v234
    v_mfma_f32_32x32x16_bf16 v[202:217], v[194:197], v[180:183], 0
    v_mfma_f32_32x32x16_bf16 v[202:217], v[198:201], v[184:187], v[202:217]
    v_perm_b32 v194, v69, v65, s61
    v_perm_b32 v195, v77, v73, s61
    v_perm_b32 v196, v85, v81, s61
    v_perm_b32 v197, v93, v89, s61
    v_perm_b32 v198, v101, v97, s61
    v_perm_b32 v199, v109, v105, s61
    v_perm_b32 v200, v113, v113, s74
    v_perm_b32 v180, v17, v13, s61
    v_perm_b32 v181, v25, v21, s61
    v_perm_b32 v182, v33, v29, s61
    v_perm_b32 v183, v41, v37, s61
    v_perm_b32 v184, v49, v45, s61
    v_perm_b32 v185, v57, v53, s61
    v_perm_b32 v186, v61, v61, s74
    v_mfma_f32_32x32x16_bf16 v[218:233], v[194:197], v[180:183], 0
    s_nop 0
    v_mfma_f32_32x32x16_bf16 v[218:233], v[198:201], v[184:187], v[218:233]
    v_perm_b32 v194, v70, v66, s60
    v_perm_b32 v195, v78, v74, s60
    v_perm_b32 v196, v86, v82, s60
    v_perm_b32 v197, v94, v90, s60
    v_perm_b32 v198, v102, v98, s60
    v_perm_b32 v199, v110, v106, s60
    v_perm_b32 v200, v114, v114, s73
    v_perm_b32 v180, v18, v14, s60
    v_perm_b32 v181, v26, v22, s60
    v_perm_b32 v182, v34, v30, s60
    v_perm_b32 v183, v42, v38, s60
    v_perm_b32 v184, v50, v46, s60
    v_perm_b32 v185, v58, v54, s60
    v_perm_b32 v186, v62, v62, s73
    v_cvt_pk_bf16_f32 v65, v202, v218
    v_cvt_pk_bf16_f32 v69, v203, v219
    v_cvt_pk_bf16_f32 v73, v204, v220
    v_cvt_pk_bf16_f32 v77, v205, v221
    v_cvt_pk_bf16_f32 v81, v206, v222
    v_cvt_pk_bf16_f32 v85, v207, v223
    v_cvt_pk_bf16_f32 v89, v208, v224
    v_cvt_pk_bf16_f32 v93, v209, v225
    v_cvt_pk_bf16_f32 v97, v210, v226
    v_cvt_pk_bf16_f32 v101, v211, v227
    v_cvt_pk_bf16_f32 v105, v212, v228
    v_cvt_pk_bf16_f32 v109, v213, v229
    v_cvt_pk_bf16_f32 v113, v214, v230
    v_dot2_f32_bf16 v234, v117, v65, v234
    v_dot2_f32_bf16 v235, v121, v69, v235
    v_dot2_f32_bf16 v236, v125, v73, v236
    v_dot2_f32_bf16 v237, v129, v77, v237
    v_dot2_f32_bf16 v234, v133, v81, v234
    v_dot2_f32_bf16 v235, v137, v85, v235
    v_dot2_f32_bf16 v236, v141, v89, v236
    v_dot2_f32_bf16 v237, v145, v93, v237
    v_dot2_f32_bf16 v234, v149, v97, v234
    v_dot2_f32_bf16 v235, v153, v101, v235
    v_dot2_f32_bf16 v236, v157, v105, v236
    v_dot2_f32_bf16 v237, v161, v109, v237
    v_dot2_f32_bf16 v234, v165, v113, v234
    v_mfma_f32_32x32x16_bf16 v[202:217], v[194:197], v[180:183], 0
    v_mfma_f32_32x32x16_bf16 v[202:217], v[198:201], v[184:187], v[202:217]
    v_perm_b32 v194, v70, v66, s61
    v_perm_b32 v195, v78, v74, s61
    v_perm_b32 v196, v86, v82, s61
    v_perm_b32 v197, v94, v90, s61
    v_perm_b32 v198, v102, v98, s61
    v_perm_b32 v199, v110, v106, s61
    v_perm_b32 v200, v114, v114, s74
    v_perm_b32 v180, v18, v14, s61
    v_perm_b32 v181, v26, v22, s61
    v_perm_b32 v182, v34, v30, s61
    v_perm_b32 v183, v42, v38, s61
    v_perm_b32 v184, v50, v46, s61
    v_perm_b32 v185, v58, v54, s61
    v_perm_b32 v186, v62, v62, s74
    v_mfma_f32_32x32x16_bf16 v[218:233], v[194:197], v[180:183], 0
    s_nop 0
    v_mfma_f32_32x32x16_bf16 v[218:233], v[198:201], v[184:187], v[218:233]
    v_perm_b32 v194, v71, v67, s60
    v_perm_b32 v195, v79, v75, s60
    v_perm_b32 v196, v87, v83, s60
    v_perm_b32 v197, v95, v91, s60
    v_perm_b32 v198, v103, v99, s60
    v_perm_b32 v199, v111, v107, s60
    v_perm_b32 v200, v115, v115, s73
    v_perm_b32 v180, v19, v15, s60
    v_perm_b32 v181, v27, v23, s60
    v_perm_b32 v182, v35, v31, s60
    v_perm_b32 v183, v43, v39, s60
    v_perm_b32 v184, v51, v47, s60
    v_perm_b32 v185, v59, v55, s60
    v_perm_b32 v186, v63, v63, s73
    v_cvt_pk_bf16_f32 v66, v202, v218
    v_cvt_pk_bf16_f32 v70, v203, v219
    v_cvt_pk_bf16_f32 v74, v204, v220
    v_cvt_pk_bf16_f32 v78, v205, v221
    v_cvt_pk_bf16_f32 v82, v206, v222
    v_cvt_pk_bf16_f32 v86, v207, v223
    v_cvt_pk_bf16_f32 v90, v208, v224
    v_cvt_pk_bf16_f32 v94, v209, v225
    v_cvt_pk_bf16_f32 v98, v210, v226
    v_cvt_pk_bf16_f32 v102, v211, v227
    v_cvt_pk_bf16_f32 v106, v212, v228
    v_cvt_pk_bf16_f32 v110, v213, v229
    v_cvt_pk_bf16_f32 v114, v214, v230
    v_dot2_f32_bf16 v234, v118, v66, v234
    v_dot2_f32_bf16 v235, v122, v70, v235
    v_dot2_f32_bf16 v236, v126, v74, v236
    v_dot2_f32_bf16 v237, v130, v78, v237
    v_dot2_f32_bf16 v234, v134, v82, v234
    v_dot2_f32_bf16 v235, v138, v86, v235
    v_dot2_f32_bf16 v236, v142, v90, v236
    v_dot2_f32_bf16 v237, v146, v94, v237
    v_dot2_f32_bf16 v234, v150, v98, v234
    v_dot2_f32_bf16 v235, v154, v102, v235
    v_dot2_f32_bf16 v236, v158, v106, v236
    v_dot2_f32_bf16 v237, v162, v110, v237
    v_dot2_f32_bf16 v234, v166, v114, v234
    v_mfma_f32_32x32x16_bf16 v[202:217], v[194:197], v[180:183], 0
    v_mfma_f32_32x32x16_bf16 v[202:217], v[198:201], v[184:187], v[202:217]
    v_perm_b32 v194, v71, v67, s61
    v_perm_b32 v195, v79, v75, s61
    v_perm_b32 v196, v87, v83, s61
    v_perm_b32 v197, v95, v91, s61
    v_perm_b32 v198, v103, v99, s61
    v_perm_b32 v199, v111, v107, s61
    v_perm_b32 v200, v115, v115, s74
    v_perm_b32 v180, v19, v15, s61
    v_perm_b32 v181, v27, v23, s61
    v_perm_b32 v182, v35, v31, s61
    v_perm_b32 v183, v43, v39, s61
    v_perm_b32 v184, v51, v47, s61
    v_perm_b32 v185, v59, v55, s61
    v_perm_b32 v186, v63, v63, s74
    v_mfma_f32_32x32x16_bf16 v[218:233], v[194:197], v[180:183], 0
    s_nop 0
    v_mfma_f32_32x32x16_bf16 v[218:233], v[198:201], v[184:187], v[218:233]
    ds_read_b32 v6, v251 offset:20
    s_waitcnt lgkmcnt(0)
    v_readfirstlane_b32 s100, v6
    s_nop 0
    s_cmp_ge_u32 s100, 1
    s_cbranch_scc1 L_sw9x
L_sw9:
    s_sleep 1
    ds_read_b32 v6, v251 offset:20
    s_waitcnt lgkmcnt(0)
    v_readfirstlane_b32 s100, v6
    s_add_u32 s59, s59, 1
    s_cmp_ge_u32 s59, 0x1000000
    s_cbranch_scc1 L_sw9x
    s_cmp_ge_u32 s100, 1
    s_cbranch_scc0 L_sw9
L_sw9x:
    s_mov_b32 s81, s100
    v_cvt_pk_bf16_f32 v67, v202, v218
    v_cvt_pk_bf16_f32 v71, v203, v219
    v_cvt_pk_bf16_f32 v75, v204, v220
    v_cvt_pk_bf16_f32 v79, v205, v221
    v_cvt_pk_bf16_f32 v83, v206, v222
    v_cvt_pk_bf16_f32 v87, v207, v223
    v_cvt_pk_bf16_f32 v91, v208, v224
    v_cvt_pk_bf16_f32 v95, v209, v225
    v_cvt_pk_bf16_f32 v99, v210, v226
    v_cvt_pk_bf16_f32 v103, v211, v227
    v_cvt_pk_bf16_f32 v107, v212, v228
    v_cvt_pk_bf16_f32 v111, v213, v229
    v_cvt_pk_bf16_f32 v115, v214, v230
    v_dot2_f32_bf16 v234, v119, v67, v234
    v_dot2_f32_bf16 v235, v123, v71, v235
    v_dot2_f32_bf16 v236, v127, v75, v236
    v_dot2_f32_bf16 v237, v131, v79, v237
    v_dot2_f32_bf16 v234, v135, v83, v234
    v_dot2_f32_bf16 v235, v139, v87, v235
    v_dot2_f32_bf16 v236, v143, v91, v236
    v_dot2_f32_bf16 v237, v147, v95, v237
    v_dot2_f32_bf16 v234, v151, v99, v234
    v_dot2_f32_bf16 v235, v155, v103, v235
    v_dot2_f32_bf16 v236, v159, v107, v236
    v_dot2_f32_bf16 v237, v163, v111, v237
    v_dot2_f32_bf16 v234, v167, v115, v234
    v_add_f32 v247, v247, v248
    s_nop 1
    s_nop 0
    v_add_f32 v234, v234, v235
    v_add_f32 v236, v236, v237
    v_add_f32 v234, v234, v247
    v_add_f32 v10, v234, v236
L_csend:
    v_mov_b32 v11, v10
    s_nop 1
    v_permlane32_swap_b32 v10, v11
    v_add_f32 v10, v10, v11
    v_min_u32 v12, -2, v10
    s_nop 1
    v_mov_b32_dpp v13, v12 quad_perm:[1,1,1,1] row_mask:0xf bank_mask:0xf bound_ctrl:0
    v_mov_b32_dpp v14, v12 quad_perm:[2,2,2,2] row_mask:0xf bank_mask:0xf bound_ctrl:0
    v_mov_b32_dpp v15, v12 quad_perm:[3,3,3,3] row_mask:0xf bank_mask:0xf bound_ctrl:0
    s_mov_b32 exec_lo, 0x11111111
    s_mov_b32 exec_hi, 0
    s_cmp_eq_u32 s81, 2
    s_cbranch_scc1 L_sn10f
    buffer_store_dwordx4 v[12:15], v8, s[44:47], s79 offen sc1
    s_branch L_sn10d
L_sn10f:
    buffer_store_dwordx4 v[12:15], v8, s[44:47], s79 offen
L_sn10d:
    s_mov_b64 exec, -1
L_fin:
L_end:
    s_endpgm
CODE_END:
.section .rodata,"a"
.p2align 6
.amdhsa_kernel standalone__deep_cross_fibinet__recsys_kernel
  .amdhsa_next_free_vgpr 256
  .amdhsa_next_free_sgpr 102
  .amdhsa_accum_offset 256
  .amdhsa_group_segment_fixed_size 0
  .amdhsa_kernarg_size 88
  .amdhsa_user_sgpr_count 2
  .amdhsa_user_sgpr_kernarg_segment_ptr 1
  .amdhsa_system_sgpr_workgroup_id_x 1
.end_amdhsa_kernel
```
